```python
import torch

def _softmax(x, axis=-1):
    return torch.softmax(x, dim=axis)

def _gelu(x):
    return torch.nn.functional.gelu(x, approximate='tanh')

def _silu(x):
    return torch.nn.functional.silu(x)

def _sigmoid(x):
    return torch.sigmoid(x)

def _layernorm(x, axis=-1, eps=1e-05):
    m = x.mean(dim=axis, keepdim=True)
    v = x.var(dim=axis, keepdim=True, unbiased=False)
    return (x - m) / torch.sqrt(v + eps)

def _scatter_add(tgt, idx, src, axis=0):
    return tgt.clone().index_add_(axis, idx, src)

def _segment_sum(src, seg, n):
    out = torch.zeros((n,) + src.shape[1:], dtype=src.dtype)
    return out.index_add_(0, seg, src)

def _pad(x, pw):
    flat = tuple((v for pair in reversed(pw) for v in pair))
    return torch.nn.functional.pad(x, flat)
kernel_name = 'adaLN_cond__grouped_kv_mqa__mixer_s_mlp__prompt'

def setup_inputs():

    _w = lambda a: (lambda t: t.to(torch.bfloat16) if t.is_floating_point() else t)(torch.as_tensor(a))

    def _A_setup():
        B, S, D, H = (1, 2048, 640, 32)
        Dh = D // H
        return {'x': _w((lambda *s: torch.randn(*s, dtype=torch.bfloat16) * 0.05)(B, S, D)), 'wq': _w((lambda *s: torch.randn(*s, dtype=torch.bfloat16) * 0.05)(D, H * Dh)), 'wk': _w((lambda *s: torch.randn(*s, dtype=torch.bfloat16) * 0.05)(D, Dh)), 'wv': _w((lambda *s: torch.randn(*s, dtype=torch.bfloat16) * 0.05)(D, Dh)), 'wo': _w((lambda *s: torch.randn(*s, dtype=torch.bfloat16) * 0.05)(H * Dh, D))}
    _A_in = _A_setup()

    def _B_setup():
        B, S, D, F = (1, 2048, 640, 1728)
        return {'x': _w((lambda *s: torch.randn(*s, dtype=torch.bfloat16) * 0.05)(B, S, D)), 'w1': _w((lambda *s: torch.randn(*s, dtype=torch.bfloat16) * 12.8)(D, D) * D ** (-0.5)), 'w2': _w((lambda *s: torch.randn(*s, dtype=torch.bfloat16) * 12.8)(D, D) * D ** (-0.5)), 'w3': _w((lambda *s: torch.randn(*s, dtype=torch.bfloat16) * 12.8)(D, F) * D ** (-0.5)), 'w4': _w((lambda *s: torch.randn(*s, dtype=torch.bfloat16) * 12.8)(F, D) * F ** (-0.5))}
    _B_in = _B_setup()
    return {'A_x': _A_in['x'], 'A_wq': _A_in['wq'], 'A_wk': _A_in['wk'], 'A_wv': _A_in['wv'], 'A_wo': _A_in['wo'], 'B_x': _B_in['x'], 'B_w1': _B_in['w1'], 'B_w2': _B_in['w2'], 'B_w3': _B_in['w3'], 'B_w4': _B_in['w4'], 'c': _w((lambda *s: torch.randn(*s, dtype=torch.bfloat16) * 0.1)(1, 640) * 8.0), 'w_mod': _w((lambda *s: torch.randn(*s, dtype=torch.bfloat16) * 0.1)(640, 6 * 640) * 640 ** (-0.5) * 8.0)}

def reference(A_x, A_wq, A_wk, A_wv, A_wo, B_x, B_w1, B_w2, B_w3, B_w4, c, w_mod):

    def _A_ref(x, wq, wk, wv, wo):
        B, S, D = x.shape
        H = 32
        Dh = D // H
        q = (lambda x, *d: x.permute(*d))((x @ wq).reshape(B, S, H, Dh), 0, 2, 1, 3)
        k = x @ wk
        v = x @ wv
        scores = torch.einsum('bhqd,bkd->bhqk', q, k) * Dh ** (-0.5)
        p = _softmax(scores, axis=-1)
        o = torch.einsum('bhqk,bkd->bhqd', p, v)
        return (lambda x, *d: x.permute(*d))(o, 0, 2, 1, 3).reshape(B, S, H * Dh) @ wo

    def _B_ref(x, w1, w2, w3, w4):
        B, S, D = x.shape
        h = _gelu(_layernorm(x, axis=-1) @ w1)
        c = D // 4
        g0 = _pad(h[:, :, 0 * c:1 * c], ((0, 0), (1, 0), (0, 0)))[:, :S, :]
        g1 = _pad(h[:, :, 1 * c:2 * c], ((0, 0), (0, 1), (0, 0)))[:, 1:, :]
        g2 = _pad(h[:, :, 2 * c:3 * c], ((0, 0), (2, 0), (0, 0)))[:, :S, :]
        g3 = _pad(h[:, :, 3 * c:], ((0, 0), (0, 2), (0, 0)))[:, 2:, :]
        hs = torch.concatenate([g0, g1, g2, g3], axis=-1) @ w2
        x1 = x + hs
        h2 = _gelu(_layernorm(x1, axis=-1) @ w3) @ w4
        return x1 + h2
    x = A_x
    mod = (_silu(c) @ w_mod).reshape(c.shape[0], 6, 1, -1)
    sa, ca, ga, sb, cb, gb = (mod[:, 0].clone(), mod[:, 1].clone(), mod[:, 2].clone(), mod[:, 3].clone(), mod[:, 4].clone(), mod[:, 5].clone())
    h = _layernorm(x, axis=-1) * (1 + ca) + sa
    x = x + ga * _A_ref(h, A_wq, A_wk, A_wv, A_wo)
    h = _layernorm(x, axis=-1) * (1 + cb) + sb
    x = x + gb * _B_ref(h, B_w1, B_w2, B_w3, B_w4)
    return x
```

```asm
; @launch grid=(256,1,1) block=(512,1,1) lds=163840
.amdgcn_target "amdgcn-amd-amdhsa--gfx950"
.text
.globl adaLN_cond__grouped_kv_mqa__mixer_s_mlp__prompt_kernel
.p2align 8
.type adaLN_cond__grouped_kv_mqa__mixer_s_mlp__prompt_kernel,@function
adaLN_cond__grouped_kv_mqa__mixer_s_mlp__prompt_kernel:
    s_cmp_ge_u32 s2, 256
    s_cbranch_scc1 L_end
    s_load_dwordx16 s[40:55], s[0:1], 0
    s_load_dwordx8 s[56:63], s[0:1], 64
    s_load_dwordx4 s[64:67], s[0:1], 96
    s_load_dwordx2 s[68:69], s[0:1], 112
    v_lshrrev_b32 v1, 6, v0
    s_and_b32 s70, s2, 7
    v_readfirstlane_b32 s74, v1
    s_lshr_b32 s71, s2, 3
    s_lshr_b32 s72, s71, 3
    s_and_b32 s73, s71, 7
    s_waitcnt lgkmcnt(0)
    s_mov_b32 s8, s68
    s_mov_b32 s9, s69
    s_mov_b32 s10, 268435456
    s_mov_b32 s11, 0x00020000
    v_and_b32 v1, 63, v0
    v_and_b32 v2, 15, v1
    v_lshrrev_b32 v3, 4, v1
    s_add_u32 s35, s2, s2
    s_add_u32 s36, s2, s2
    s_add_u32 s38, s2, s2
    s_add_u32 s39, s2, s2
    s_add_u32 s81, s2, s2
    s_add_u32 s85, s2, s2
    s_add_u32 s86, s2, s2
    s_add_u32 s87, s2, s2
    s_add_u32 s90, s2, s2
    s_add_u32 s92, s2, s2
    s_add_u32 s93, s2, s2
    s_add_u32 s94, s2, s2
    s_add_u32 s100, s2, s2
    s_cmp_lg_u32 s74, 6
    s_cbranch_scc1 L_cpf_1
    s_getpc_b64 s[24:25]
L_cpf_pc:
    s_mov_b32 s26, L_end-L_cpf_pc
    v_lshlrev_b32 v10, 7, v1
    v_mov_b32 v9, s25
    v_add_co_u32 v8, vcc, s24, v10
    s_nop 1
    v_addc_co_u32 v9, vcc, 0, v9, vcc
    v_cmp_gt_u32 vcc, s26, v10
    s_and_saveexec_b64 s[30:31], vcc
    s_cbranch_execz L_cpq_2
    global_load_dword v230, v[8:9], off
L_cpq_2:
    s_mov_b64 exec, s[30:31]
    v_add_u32 v10, 0x2000, v10
    v_add_co_u32 v8, vcc, 0x2000, v8
    s_nop 1
    v_addc_co_u32 v9, vcc, 0, v9, vcc
    v_cmp_gt_u32 vcc, s26, v10
    s_and_saveexec_b64 s[30:31], vcc
    s_cbranch_execz L_cpq_3
    global_load_dword v231, v[8:9], off
L_cpq_3:
    s_mov_b64 exec, s[30:31]
    v_add_u32 v10, 0x2000, v10
    v_add_co_u32 v8, vcc, 0x2000, v8
    s_nop 1
    v_addc_co_u32 v9, vcc, 0, v9, vcc
    v_cmp_gt_u32 vcc, s26, v10
    s_and_saveexec_b64 s[30:31], vcc
    s_cbranch_execz L_cpq_4
    global_load_dword v232, v[8:9], off
L_cpq_4:
    s_mov_b64 exec, s[30:31]
    v_add_u32 v10, 0x2000, v10
    v_add_co_u32 v8, vcc, 0x2000, v8
    s_nop 1
    v_addc_co_u32 v9, vcc, 0, v9, vcc
    v_cmp_gt_u32 vcc, s26, v10
    s_and_saveexec_b64 s[30:31], vcc
    s_cbranch_execz L_cpq_5
    global_load_dword v233, v[8:9], off
L_cpq_5:
    s_mov_b64 exec, s[30:31]
    v_add_u32 v10, 0x2000, v10
    v_add_co_u32 v8, vcc, 0x2000, v8
    s_nop 1
    v_addc_co_u32 v9, vcc, 0, v9, vcc
    v_cmp_gt_u32 vcc, s26, v10
    s_and_saveexec_b64 s[30:31], vcc
    s_cbranch_execz L_cpq_6
    global_load_dword v234, v[8:9], off
L_cpq_6:
    s_mov_b64 exec, s[30:31]
    v_add_u32 v10, 0x2000, v10
    v_add_co_u32 v8, vcc, 0x2000, v8
    s_nop 1
    v_addc_co_u32 v9, vcc, 0, v9, vcc
    v_cmp_gt_u32 vcc, s26, v10
    s_and_saveexec_b64 s[30:31], vcc
    s_cbranch_execz L_cpq_7
    global_load_dword v235, v[8:9], off
L_cpq_7:
    s_mov_b64 exec, s[30:31]
    v_add_u32 v10, 0x2000, v10
    v_add_co_u32 v8, vcc, 0x2000, v8
    s_nop 1
    v_addc_co_u32 v9, vcc, 0, v9, vcc
L_cpf_1:
    s_getreg_b32 s4, hwreg(HW_REG_XCC_ID, 0, 4)
    s_mov_b32 s20, s66
    s_mov_b32 s21, s67
    s_mov_b32 s22, 256
    s_mov_b32 s23, 0x00020000
    s_and_b32 s75, s74, 3
    s_lshr_b32 s76, s74, 2
    s_lshl_b32 s77, s70, 8
    s_lshl_b32 s24, s72, 6
    s_add_u32 s77, s77, s24
    s_lshr_b32 s78, s77, 4
    s_add_u32 s78, s78, s75
    v_lshlrev_b32 v6, 4, v1
    s_cmp_lg_u32 s74, 0
    s_cbranch_scc1 L_f_w0
    s_cmp_lg_u32 s2, 0
    s_cbranch_scc1 L_f_non
    s_memrealtime s[24:25]
    s_waitcnt lgkmcnt(0)
    s_or_b32 s24, s24, 1
    v_mov_b32 v8, s24
    v_mov_b32 v9, 128
    s_mov_b64 exec, 1
    buffer_store_dword v8, v9, s[20:23], 0 offen sc1
    s_mov_b64 exec, -1
L_f_non:
    s_mul_i32 s32, s70, 10
    s_add_u32 s32, s32, s71
    s_mul_i32 s26, s70, 20
    s_add_u32 s26, s26, s71
    s_add_u32 s26, s26, 70
    s_cmp_lt_u32 s71, 10
    s_cselect_b32 s32, s32, s26
    s_cmp_lt_u32 s71, 30
    s_cselect_b32 s32, s32, 255
    s_mov_b32 s12, s60
    s_mov_b32 s13, s61
    s_mov_b32 s14, 1280
    s_mov_b32 s15, 0x00020000
    s_mov_b32 s16, s62
    s_mov_b32 s17, s63
    s_mov_b32 s18, 4915200
    s_mov_b32 s19, 0x00020000
    s_mov_b32 m0, 133184
    v_lshrrev_b32 v7, 1, v1
    buffer_load_dwordx4 v6, s[12:15], 0 offen lds
    buffer_load_dwordx4 v6, s[12:15], 0 offen offset:1024 lds
    v_mul_u32_u24 v7, 7680, v7
    v_and_b32 v8, 1, v1
    v_lshl_add_u32 v7, v8, 4, v7
    s_lshl_b32 s25, s32, 5
    s_min_u32 s25, s25, 7648
    s_mov_b32 s26, 143360
    s_movk_i32 s27, 20
L_f_ml:
    s_mov_b32 m0, s26
    s_add_u32 s26, s26, 1024
    buffer_load_dwordx4 v7, s[16:19], s25 offen lds
    s_add_u32 s25, s25, 245760
    s_sub_u32 s27, s27, 1
    s_cmp_lg_u32 s27, 0
    s_cbranch_scc1 L_f_ml
    v_mov_b32 v10, 128
    buffer_load_dword v11, v10, s[20:23], 0 offen sc1
    s_barrier
    s_branch L_f_m
L_f_w0:
    s_mov_b32 s16, s40
    s_mov_b32 s17, s41
    s_mov_b32 s18, 2621440
    s_mov_b32 s19, 0x00020000
    v_lshrrev_b32 v7, 2, v1
    v_and_b32 v8, 3, v1
    v_bfe_u32 v9, v7, 1, 2
    v_xor_b32 v8, v8, v9
    v_mul_u32_u24 v7, 1280, v7
    v_lshl_add_u32 v9, v8, 4, v7
    s_lshr_b32 s24, s74, 1
    s_lshl_b32 s24, s24, 4
    s_add_u32 s24, s24, s77
    s_mul_i32 s24, s24, 1280
    s_and_b32 s25, s74, 1
    s_mul_i32 s25, s25, 640
    s_add_u32 s24, s24, s25
    s_mul_i32 s25, s74, 10240
    s_mov_b32 m0, s25
    s_add_u32 s26, s25, 4096
    s_add_u32 s27, s25, 8192
    s_barrier
    buffer_load_dwordx4 v9, s[16:19], s24 offen lds
    s_add_u32 m0, s25, 1024
    s_add_u32 s24, s24, 64
    buffer_load_dwordx4 v9, s[16:19], s24 offen lds
    s_add_u32 m0, s25, 2048
    s_add_u32 s24, s24, 64
    buffer_load_dwordx4 v9, s[16:19], s24 offen lds
    s_add_u32 m0, s25, 3072
    s_add_u32 s24, s24, 64
    buffer_load_dwordx4 v9, s[16:19], s24 offen lds
    s_add_u32 m0, s25, 4096
    s_add_u32 s24, s24, 64
    buffer_load_dwordx4 v9, s[16:19], s24 offen lds
    s_add_u32 m0, s25, 5120
    s_add_u32 s24, s24, 64
    buffer_load_dwordx4 v9, s[16:19], s24 offen lds
    s_add_u32 m0, s25, 6144
    s_add_u32 s24, s24, 64
    buffer_load_dwordx4 v9, s[16:19], s24 offen lds
    s_add_u32 m0, s25, 7168
    s_add_u32 s24, s24, 64
    buffer_load_dwordx4 v9, s[16:19], s24 offen lds
    s_add_u32 m0, s25, 8192
    s_add_u32 s24, s24, 64
    buffer_load_dwordx4 v9, s[16:19], s24 offen lds
    s_add_u32 m0, s25, 9216
    s_add_u32 s24, s24, 64
    buffer_load_dwordx4 v9, s[16:19], s24 offen lds
    s_cmp_ge_u32 s74, 6
    s_cbranch_scc1 L_f_x0
    s_sub_u32 s25, s74, 1
    s_lshl_b32 s26, s25, 7
    s_mul_i32 s24, s77, 1280
    s_add_u32 s24, s24, s26
    s_lshl_b32 s25, s25, 11
    s_mov_b32 m0, s25
    s_add_u32 s26, s24, 64
    buffer_load_dwordx4 v9, s[16:19], s24 offen lds
    s_add_u32 m0, s25, 1024
    s_nop 0
    buffer_load_dwordx4 v9, s[16:19], s26 offen lds
L_f_x0:
    s_mov_b32 s12, s42
    s_mov_b32 s13, s43
    s_mov_b32 s14, 819200
    s_mov_b32 s15, 0x00020000
    v_add_u32 v7, 0, v1
    v_mul_u32_u24 v8, 6554, v7
    v_lshrrev_b32 v8, 16, v8
    v_mul_u32_u24 v10, 10, v8
    v_sub_u32 v7, v7, v10
    v_mul_u32_u24 v8, 1280, v8
    v_lshl_add_u32 v240, v7, 4, v8
    v_add_u32 v7, 64, v1
    v_mul_u32_u24 v8, 6554, v7
    v_lshrrev_b32 v8, 16, v8
    v_mul_u32_u24 v10, 10, v8
    v_sub_u32 v7, v7, v10
    v_mul_u32_u24 v8, 1280, v8
    v_lshl_add_u32 v241, v7, 4, v8
    v_add_u32 v7, 128, v1
    v_mul_u32_u24 v8, 6554, v7
    v_lshrrev_b32 v8, 16, v8
    v_mul_u32_u24 v10, 10, v8
    v_sub_u32 v7, v7, v10
    v_mul_u32_u24 v8, 1280, v8
    v_lshl_add_u32 v242, v7, 4, v8
    v_add_u32 v7, 192, v1
    v_mul_u32_u24 v8, 6554, v7
    v_lshrrev_b32 v8, 16, v8
    v_mul_u32_u24 v10, 10, v8
    v_sub_u32 v7, v7, v10
    v_mul_u32_u24 v8, 1280, v8
    v_lshl_add_u32 v243, v7, 4, v8
    v_add_u32 v7, 256, v1
    v_mul_u32_u24 v8, 6554, v7
    v_lshrrev_b32 v8, 16, v8
    v_mul_u32_u24 v10, 10, v8
    v_sub_u32 v7, v7, v10
    v_mul_u32_u24 v8, 1280, v8
    v_lshl_add_u32 v244, v7, 4, v8
    s_mul_i32 s34, s73, 160
    s_sub_u32 s24, s74, 1
    s_mul_i32 s25, s24, 40960
    s_add_u32 s25, s25, s34
    s_mul_i32 s26, s24, 5120
    s_add_u32 s26, s26, 81920
    s_add_u32 m0, s26, 0
    s_nop 0
    buffer_load_dwordx4 v240, s[12:15], s25 offen lds
    s_add_u32 m0, s26, 1024
    s_nop 0
    buffer_load_dwordx4 v241, s[12:15], s25 offen lds
    s_add_u32 m0, s26, 2048
    s_nop 0
    buffer_load_dwordx4 v242, s[12:15], s25 offen lds
    s_add_u32 m0, s26, 3072
    s_nop 0
    buffer_load_dwordx4 v243, s[12:15], s25 offen lds
    s_add_u32 m0, s26, 4096
    s_nop 0
    buffer_load_dwordx4 v244, s[12:15], s25 offen lds
    s_cmp_lt_u32 s74, 5
    s_cbranch_scc1 L_f_xw
    s_add_u32 s24, s74, 2
    s_mul_i32 s25, s24, 40960
    s_add_u32 s25, s25, s34
    s_mul_i32 s26, s24, 5120
    s_add_u32 s26, s26, 81920
    s_add_u32 m0, s26, 0
    s_nop 0
    buffer_load_dwordx4 v240, s[12:15], s25 offen lds
    s_add_u32 m0, s26, 1024
    s_nop 0
    buffer_load_dwordx4 v241, s[12:15], s25 offen lds
    s_add_u32 m0, s26, 2048
    s_nop 0
    buffer_load_dwordx4 v242, s[12:15], s25 offen lds
    s_add_u32 m0, s26, 3072
    s_nop 0
    buffer_load_dwordx4 v243, s[12:15], s25 offen lds
    s_add_u32 m0, s26, 4096
    s_nop 0
    buffer_load_dwordx4 v244, s[12:15], s25 offen lds
    s_waitcnt vmcnt(10)
    s_branch L_f_xb
L_f_m:
    s_mov_b32 s12, s42
    s_mov_b32 s13, s43
    s_mov_b32 s14, 819200
    s_mov_b32 s15, 0x00020000
    v_add_u32 v7, 0, v1
    v_mul_u32_u24 v8, 6554, v7
    v_lshrrev_b32 v8, 16, v8
    v_mul_u32_u24 v10, 10, v8
    v_sub_u32 v7, v7, v10
    v_mul_u32_u24 v8, 1280, v8
    v_lshl_add_u32 v240, v7, 4, v8
    v_add_u32 v7, 64, v1
    v_mul_u32_u24 v8, 6554, v7
    v_lshrrev_b32 v8, 16, v8
    v_mul_u32_u24 v10, 10, v8
    v_sub_u32 v7, v7, v10
    v_mul_u32_u24 v8, 1280, v8
    v_lshl_add_u32 v241, v7, 4, v8
    v_add_u32 v7, 128, v1
    v_mul_u32_u24 v8, 6554, v7
    v_lshrrev_b32 v8, 16, v8
    v_mul_u32_u24 v10, 10, v8
    v_sub_u32 v7, v7, v10
    v_mul_u32_u24 v8, 1280, v8
    v_lshl_add_u32 v242, v7, 4, v8
    v_add_u32 v7, 192, v1
    v_mul_u32_u24 v8, 6554, v7
    v_lshrrev_b32 v8, 16, v8
    v_mul_u32_u24 v10, 10, v8
    v_sub_u32 v7, v7, v10
    v_mul_u32_u24 v8, 1280, v8
    v_lshl_add_u32 v243, v7, 4, v8
    v_add_u32 v7, 256, v1
    v_mul_u32_u24 v8, 6554, v7
    v_lshrrev_b32 v8, 16, v8
    v_mul_u32_u24 v10, 10, v8
    v_sub_u32 v7, v7, v10
    v_mul_u32_u24 v8, 1280, v8
    v_lshl_add_u32 v244, v7, 4, v8
    s_mul_i32 s34, s73, 160
    s_waitcnt vmcnt(21)
    v_lshlrev_b32 v7, 1, v1
    v_add_u32 v7, 133184, v7
    ds_read_u16 v12, v7 offset:0
    ds_read_u16 v13, v7 offset:128
    ds_read_u16 v14, v7 offset:256
    ds_read_u16 v15, v7 offset:384
    ds_read_u16 v16, v7 offset:512
    ds_read_u16 v17, v7 offset:640
    ds_read_u16 v18, v7 offset:768
    ds_read_u16 v19, v7 offset:896
    ds_read_u16 v20, v7 offset:1024
    ds_read_u16 v21, v7 offset:1152
    s_waitcnt lgkmcnt(0)
    v_lshlrev_b32 v12, 16, v12
    v_lshlrev_b32 v13, 16, v13
    v_lshlrev_b32 v14, 16, v14
    v_lshlrev_b32 v15, 16, v15
    v_lshlrev_b32 v16, 16, v16
    v_lshlrev_b32 v17, 16, v17
    v_lshlrev_b32 v18, 16, v18
    v_lshlrev_b32 v19, 16, v19
    v_lshlrev_b32 v20, 16, v20
    v_lshlrev_b32 v21, 16, v21
    v_mul_f32 v22, 0xbfb8aa3b, v12
    v_mul_f32 v23, 0xbfb8aa3b, v13
    v_mul_f32 v24, 0xbfb8aa3b, v14
    v_mul_f32 v25, 0xbfb8aa3b, v15
    v_mul_f32 v26, 0xbfb8aa3b, v16
    v_mul_f32 v27, 0xbfb8aa3b, v17
    v_mul_f32 v28, 0xbfb8aa3b, v18
    v_mul_f32 v29, 0xbfb8aa3b, v19
    v_mul_f32 v30, 0xbfb8aa3b, v20
    v_mul_f32 v31, 0xbfb8aa3b, v21
    v_exp_f32 v22, v22
    v_exp_f32 v23, v23
    v_exp_f32 v24, v24
    v_exp_f32 v25, v25
    v_exp_f32 v26, v26
    v_exp_f32 v27, v27
    v_exp_f32 v28, v28
    v_exp_f32 v29, v29
    v_exp_f32 v30, v30
    v_exp_f32 v31, v31
    v_add_f32 v22, 1.0, v22
    v_add_f32 v23, 1.0, v23
    v_add_f32 v24, 1.0, v24
    v_add_f32 v25, 1.0, v25
    v_add_f32 v26, 1.0, v26
    v_add_f32 v27, 1.0, v27
    v_add_f32 v28, 1.0, v28
    v_add_f32 v29, 1.0, v29
    v_add_f32 v30, 1.0, v30
    v_add_f32 v31, 1.0, v31
    v_rcp_f32 v22, v22
    v_rcp_f32 v23, v23
    v_rcp_f32 v24, v24
    v_rcp_f32 v25, v25
    v_rcp_f32 v26, v26
    v_rcp_f32 v27, v27
    v_rcp_f32 v28, v28
    v_rcp_f32 v29, v29
    v_rcp_f32 v30, v30
    v_rcp_f32 v31, v31
    v_mul_f32 v12, v12, v22
    v_mul_f32 v13, v13, v23
    v_mul_f32 v14, v14, v24
    v_mul_f32 v15, v15, v25
    v_mul_f32 v16, v16, v26
    v_mul_f32 v17, v17, v27
    v_mul_f32 v18, v18, v28
    v_mul_f32 v19, v19, v29
    v_mul_f32 v20, v20, v30
    v_mul_f32 v21, v21, v31
    v_cvt_pk_bf16_f32 v12, v12, v12
    v_cvt_pk_bf16_f32 v13, v13, v13
    v_cvt_pk_bf16_f32 v14, v14, v14
    v_cvt_pk_bf16_f32 v15, v15, v15
    v_cvt_pk_bf16_f32 v16, v16, v16
    v_cvt_pk_bf16_f32 v17, v17, v17
    v_cvt_pk_bf16_f32 v18, v18, v18
    v_cvt_pk_bf16_f32 v19, v19, v19
    v_cvt_pk_bf16_f32 v20, v20, v20
    v_cvt_pk_bf16_f32 v21, v21, v21
    v_add_u32 v7, 1984, v7
    ds_write_b16 v7, v12 offset:0
    ds_write_b16 v7, v13 offset:128
    ds_write_b16 v7, v14 offset:256
    ds_write_b16 v7, v15 offset:384
    ds_write_b16 v7, v16 offset:512
    ds_write_b16 v7, v17 offset:640
    ds_write_b16 v7, v18 offset:768
    ds_write_b16 v7, v19 offset:896
    ds_write_b16 v7, v20 offset:1024
    ds_write_b16 v7, v21 offset:1152
    v_lshrrev_b32 v8, 2, v2
    v_lshl_add_u32 v8, v3, 2, v8
    v_lshlrev_b32 v8, 5, v8
    v_and_b32 v10, 3, v2
    v_lshl_add_u32 v8, v10, 3, v8
    v_add_u32 v8, 143360, v8
    v_lshlrev_b32 v98, 3, v3
    v_add_u32 v98, 135168, v98
    v_mov_b32 v12, 0
    v_mov_b32 v13, 0
    v_mov_b32 v14, 0
    v_mov_b32 v15, 0
    s_waitcnt vmcnt(0) lgkmcnt(0)
    ds_read_b64_tr_b16 v[16:17], v8 offset:0
    ds_read_b64_tr_b16 v[18:19], v8 offset:512
    ds_read_b64 v[20:21], v98 offset:0
    ds_read_b64 v[22:23], v98 offset:32
    ds_read_b64_tr_b16 v[24:25], v8 offset:1024
    ds_read_b64_tr_b16 v[26:27], v8 offset:1536
    ds_read_b64 v[28:29], v98 offset:64
    ds_read_b64 v[30:31], v98 offset:96
    ds_read_b64_tr_b16 v[32:33], v8 offset:2048
    ds_read_b64_tr_b16 v[34:35], v8 offset:2560
    ds_read_b64 v[36:37], v98 offset:128
    ds_read_b64 v[38:39], v98 offset:160
    s_waitcnt lgkmcnt(4)
    ds_read_b64_tr_b16 v[40:41], v8 offset:3072
    ds_read_b64_tr_b16 v[42:43], v8 offset:3584
    ds_read_b64 v[44:45], v98 offset:192
    ds_read_b64 v[46:47], v98 offset:224
    ds_read_b64_tr_b16 v[48:49], v8 offset:4096
    ds_read_b64_tr_b16 v[50:51], v8 offset:4608
    ds_read_b64 v[52:53], v98 offset:256
    ds_read_b64 v[54:55], v98 offset:288
    s_waitcnt lgkmcnt(4)
    ds_read_b64_tr_b16 v[56:57], v8 offset:5120
    ds_read_b64_tr_b16 v[58:59], v8 offset:5632
    ds_read_b64 v[60:61], v98 offset:320
    ds_read_b64 v[62:63], v98 offset:352
    ds_read_b64_tr_b16 v[64:65], v8 offset:6144
    ds_read_b64_tr_b16 v[66:67], v8 offset:6656
    ds_read_b64 v[68:69], v98 offset:384
    ds_read_b64 v[70:71], v98 offset:416
    s_waitcnt lgkmcnt(4)
    ds_read_b64_tr_b16 v[72:73], v8 offset:7168
    ds_read_b64_tr_b16 v[74:75], v8 offset:7680
    ds_read_b64 v[76:77], v98 offset:448
    ds_read_b64 v[78:79], v98 offset:480
    ds_read_b64_tr_b16 v[80:81], v8 offset:8192
    ds_read_b64_tr_b16 v[82:83], v8 offset:8704
    ds_read_b64 v[84:85], v98 offset:512
    ds_read_b64 v[86:87], v98 offset:544
    s_waitcnt lgkmcnt(4)
    ds_read_b64_tr_b16 v[88:89], v8 offset:9216
    ds_read_b64_tr_b16 v[90:91], v8 offset:9728
    ds_read_b64 v[92:93], v98 offset:576
    ds_read_b64 v[94:95], v98 offset:608
    s_waitcnt lgkmcnt(0)
    v_mfma_f32_16x16x32_bf16 v[12:15], v[16:19], v[20:23], v[12:15]
    v_mfma_f32_16x16x32_bf16 v[12:15], v[24:27], v[28:31], v[12:15]
    v_mfma_f32_16x16x32_bf16 v[12:15], v[32:35], v[36:39], v[12:15]
    v_mfma_f32_16x16x32_bf16 v[12:15], v[40:43], v[44:47], v[12:15]
    v_mfma_f32_16x16x32_bf16 v[12:15], v[48:51], v[52:55], v[12:15]
    v_mfma_f32_16x16x32_bf16 v[12:15], v[56:59], v[60:63], v[12:15]
    v_mfma_f32_16x16x32_bf16 v[12:15], v[64:67], v[68:71], v[12:15]
    v_mfma_f32_16x16x32_bf16 v[12:15], v[72:75], v[76:79], v[12:15]
    v_mfma_f32_16x16x32_bf16 v[12:15], v[80:83], v[84:87], v[12:15]
    v_mfma_f32_16x16x32_bf16 v[12:15], v[88:91], v[92:95], v[12:15]
    ds_read_b64_tr_b16 v[16:17], v8 offset:10240
    ds_read_b64_tr_b16 v[18:19], v8 offset:10752
    ds_read_b64 v[20:21], v98 offset:640
    ds_read_b64 v[22:23], v98 offset:672
    ds_read_b64_tr_b16 v[24:25], v8 offset:11264
    ds_read_b64_tr_b16 v[26:27], v8 offset:11776
    ds_read_b64 v[28:29], v98 offset:704
    ds_read_b64 v[30:31], v98 offset:736
    ds_read_b64_tr_b16 v[32:33], v8 offset:12288
    ds_read_b64_tr_b16 v[34:35], v8 offset:12800
    ds_read_b64 v[36:37], v98 offset:768
    ds_read_b64 v[38:39], v98 offset:800
    s_waitcnt lgkmcnt(4)
    ds_read_b64_tr_b16 v[40:41], v8 offset:13312
    ds_read_b64_tr_b16 v[42:43], v8 offset:13824
    ds_read_b64 v[44:45], v98 offset:832
    ds_read_b64 v[46:47], v98 offset:864
    ds_read_b64_tr_b16 v[48:49], v8 offset:14336
    ds_read_b64_tr_b16 v[50:51], v8 offset:14848
    ds_read_b64 v[52:53], v98 offset:896
    ds_read_b64 v[54:55], v98 offset:928
    s_waitcnt lgkmcnt(4)
    ds_read_b64_tr_b16 v[56:57], v8 offset:15360
    ds_read_b64_tr_b16 v[58:59], v8 offset:15872
    ds_read_b64 v[60:61], v98 offset:960
    ds_read_b64 v[62:63], v98 offset:992
    ds_read_b64_tr_b16 v[64:65], v8 offset:16384
    ds_read_b64_tr_b16 v[66:67], v8 offset:16896
    ds_read_b64 v[68:69], v98 offset:1024
    ds_read_b64 v[70:71], v98 offset:1056
    s_waitcnt lgkmcnt(4)
    ds_read_b64_tr_b16 v[72:73], v8 offset:17408
    ds_read_b64_tr_b16 v[74:75], v8 offset:17920
    ds_read_b64 v[76:77], v98 offset:1088
    ds_read_b64 v[78:79], v98 offset:1120
    ds_read_b64_tr_b16 v[80:81], v8 offset:18432
    ds_read_b64_tr_b16 v[82:83], v8 offset:18944
    ds_read_b64 v[84:85], v98 offset:1152
    ds_read_b64 v[86:87], v98 offset:1184
    s_waitcnt lgkmcnt(4)
    ds_read_b64_tr_b16 v[88:89], v8 offset:19456
    ds_read_b64_tr_b16 v[90:91], v8 offset:19968
    ds_read_b64 v[92:93], v98 offset:1216
    ds_read_b64 v[94:95], v98 offset:1248
    s_waitcnt lgkmcnt(0)
    v_mfma_f32_16x16x32_bf16 v[12:15], v[16:19], v[20:23], v[12:15]
    v_mfma_f32_16x16x32_bf16 v[12:15], v[24:27], v[28:31], v[12:15]
    v_mfma_f32_16x16x32_bf16 v[12:15], v[32:35], v[36:39], v[12:15]
    v_mfma_f32_16x16x32_bf16 v[12:15], v[40:43], v[44:47], v[12:15]
    v_mfma_f32_16x16x32_bf16 v[12:15], v[48:51], v[52:55], v[12:15]
    v_mfma_f32_16x16x32_bf16 v[12:15], v[56:59], v[60:63], v[12:15]
    v_mfma_f32_16x16x32_bf16 v[12:15], v[64:67], v[68:71], v[12:15]
    v_mfma_f32_16x16x32_bf16 v[12:15], v[72:75], v[76:79], v[12:15]
    v_mfma_f32_16x16x32_bf16 v[12:15], v[80:83], v[84:87], v[12:15]
    v_mfma_f32_16x16x32_bf16 v[12:15], v[88:91], v[92:95], v[12:15]
    s_mov_b32 s101, 0x40000
L_f_npl:
    v_readfirstlane_b32 s79, v11
    s_sub_u32 s101, s101, 1
    s_cmp_lg_u32 s79, 0
    s_cbranch_scc1 L_f_npd
    s_cmp_eq_u32 s101, 0
    s_cbranch_scc1 L_f_npd
    v_mov_b32 v10, 128
    buffer_load_dword v11, v10, s[20:23], 0 offen sc1
    s_waitcnt vmcnt(0)
    s_branch L_f_npl
L_f_npd:
    v_mov_b32 v10, 133120
    ds_write_b32 v10, v11
    s_cmp_ge_u32 s32, 240
    s_cbranch_scc1 L_f_pb2
    v_cvt_pk_bf16_f32 v16, v12, v13
    v_cvt_pk_bf16_f32 v17, v14, v15
    v_lshlrev_b32 v20, 16, v16
    v_mov_b32 v21, s79
    v_and_b32 v22, 0xffff0000, v16
    v_mov_b32 v23, s79
    v_lshlrev_b32 v24, 16, v17
    v_mov_b32 v25, s79
    v_and_b32 v26, 0xffff0000, v17
    v_mov_b32 v27, s79
    v_lshlrev_b32 v18, 5, v3
    s_lshl_b32 s24, s32, 7
    s_add_u32 s24, s24, 31784960
    s_mov_b32 exec_lo, 0x00010001
    s_mov_b32 exec_hi, 0x00010001
    buffer_store_dwordx4 v[20:23], v18, s[8:11], s24 offen sc1
    buffer_store_dwordx4 v[24:27], v18, s[8:11], s24 offen offset:16 sc1
    s_mov_b64 exec, -1
L_f_pb2:
    s_and_b32 s26, s79, 0xfffffff0
    s_or_b32 s26, s26, s4
    v_mov_b32 v8, s26
    s_lshl_b32 s26, s70, 5
    s_add_u32 s26, s26, s71
    s_lshl_b32 s26, s26, 2
    s_add_u32 s26, s26, 90112
    v_mov_b32 v9, 0
    s_mov_b64 exec, 1
    buffer_store_dword v8, v9, s[8:11], s26 offen sc1
    s_mov_b64 exec, -1
    s_waitcnt lgkmcnt(0)
    s_branch L_f_xb
L_f_xw:
    s_waitcnt vmcnt(5)
L_f_xb:
    s_barrier
    v_mov_b32 v7, 133120
    ds_read_b32 v11, v7
    v_lshrrev_b32 v4, 1, v3
    v_bfe_u32 v5, v2, 1, 2
    v_xor_b32 v4, v4, v5
    v_lshlrev_b32 v4, 4, v4
    v_lshl_add_u32 v4, v2, 6, v4
    v_and_b32 v5, 1, v3
    v_lshl_add_u32 v4, v5, 3, v4
    s_mul_i32 s24, s75, 20480
    s_mul_i32 s25, s76, 5120
    s_add_u32 s24, s24, s25
    v_add_u32 v4, s24, v4
    v_xor_b32 v5, 32, v4
    ds_read_b64 v[100:101], v4 offset:0
    ds_read_b64 v[102:103], v5 offset:0
    ds_read_b64 v[104:105], v4 offset:1024
    ds_read_b64 v[106:107], v5 offset:1024
    ds_read_b64 v[108:109], v4 offset:2048
    ds_read_b64 v[110:111], v5 offset:2048
    ds_read_b64 v[112:113], v4 offset:3072
    ds_read_b64 v[114:115], v5 offset:3072
    ds_read_b64 v[116:117], v4 offset:4096
    ds_read_b64 v[118:119], v5 offset:4096
    ds_read_b64 v[120:121], v4 offset:10240
    ds_read_b64 v[122:123], v5 offset:10240
    ds_read_b64 v[124:125], v4 offset:11264
    ds_read_b64 v[126:127], v5 offset:11264
    ds_read_b64 v[128:129], v4 offset:12288
    ds_read_b64 v[130:131], v5 offset:12288
    ds_read_b64 v[132:133], v4 offset:13312
    ds_read_b64 v[134:135], v5 offset:13312
    ds_read_b64 v[136:137], v4 offset:14336
    ds_read_b64 v[138:139], v5 offset:14336
    s_waitcnt lgkmcnt(0)
    v_readfirstlane_b32 s79, v11
    s_barrier
    s_cmp_ge_u32 s73, 2
    s_cbranch_scc1 L_f_nokv
    s_cmp_eq_u32 s73, 0
    s_cselect_b32 s16, s44, s46
    s_cselect_b32 s17, s45, s47
    s_mov_b32 s18, 25600
    s_mov_b32 s19, 0x00020000
    s_add_u32 s24, s74, 0
    s_lshl_b32 s25, s24, 10
    s_add_u32 s26, s25, 51200
    s_cmp_lt_u32 s24, 25
    s_cselect_b32 s26, s26, 138240
    s_mov_b32 m0, s26
    s_nop 0
    buffer_load_dwordx4 v6, s[16:19], s25 offen lds
    s_add_u32 s24, s74, 8
    s_lshl_b32 s25, s24, 10
    s_add_u32 s26, s25, 51200
    s_cmp_lt_u32 s24, 25
    s_cselect_b32 s26, s26, 138240
    s_mov_b32 m0, s26
    s_nop 0
    buffer_load_dwordx4 v6, s[16:19], s25 offen lds
    s_add_u32 s24, s74, 16
    s_lshl_b32 s25, s24, 10
    s_add_u32 s26, s25, 51200
    s_cmp_lt_u32 s24, 25
    s_cselect_b32 s26, s26, 138240
    s_mov_b32 m0, s26
    s_nop 0
    buffer_load_dwordx4 v6, s[16:19], s25 offen lds
    s_add_u32 s24, s74, 24
    s_lshl_b32 s25, s24, 10
    s_add_u32 s26, s25, 51200
    s_cmp_lt_u32 s24, 25
    s_cselect_b32 s26, s26, 138240
    s_mov_b32 m0, s26
    s_nop 0
    buffer_load_dwordx4 v6, s[16:19], s25 offen lds
L_f_nokv:
    s_cmp_lg_u32 s74, 4
    s_cbranch_scc1 L_f_z
    v_mov_b32 v8, 0
    v_mov_b32 v9, 0
    v_mov_b32 v10, 0
    v_mov_b32 v11, 0
    s_cmp_ge_u32 s2, 16
    s_cbranch_scc1 L_f_z1
    s_lshl_b32 s26, s2, 10
    s_add_u32 s26, s26, 16384
    buffer_store_dwordx4 v[8:11], v6, s[8:11], s26 offen sc1
L_f_z1:
    s_lshl_b32 s24, s70, 2
    s_add_u32 s24, s24, s72
    s_mov_b32 s25, 0
    s_cmp_eq_u32 s24, 0
    s_cbranch_scc1 L_f_z2
    s_mov_b32 s25, 32896
    s_cmp_eq_u32 s24, 31
    s_cbranch_scc0 L_f_z
L_f_z2:
    s_mul_i32 s26, s73, 330240
    s_add_u32 s26, s26, s25
    s_add_u32 s26, s26, 13631488
    v_lshrrev_b32 v13, 3, v1
    v_mul_u32_u24 v13, 33024, v13
    v_and_b32 v12, 7, v1
    v_lshl_add_u32 v12, v12, 4, v13
    buffer_store_dwordx4 v[8:11], v12, s[8:11], s26 offen sc1
    s_add_u32 s26, s26, 264192
    s_mov_b64 exec, 0xffff
    buffer_store_dwordx4 v[8:11], v12, s[8:11], s26 offen sc1
    s_mov_b64 exec, -1
L_f_z:
    v_mov_b32 v48, 0x3f803f80
    v_mov_b32 v49, 0x3f803f80
    v_mov_b32 v50, 0x3f803f80
    v_mov_b32 v51, 0x3f803f80
    v_mov_b32 v52, 0
    v_mov_b32 v53, 0
    v_mov_b32 v54, 0
    v_mov_b32 v55, 0
    v_mov_b32 v56, 0
    v_mov_b32 v57, 0
    v_mov_b32 v58, 0
    v_mov_b32 v59, 0
    s_nop 0
    v_mfma_f32_16x16x32_bf16 v[52:55], v[48:51], v[100:103], v[52:55]
    v_mfma_f32_16x16x32_bf16 v[56:59], v[100:103], v[100:103], v[56:59]
    v_mfma_f32_16x16x32_bf16 v[52:55], v[48:51], v[104:107], v[52:55]
    v_mfma_f32_16x16x32_bf16 v[56:59], v[104:107], v[104:107], v[56:59]
    v_mfma_f32_16x16x32_bf16 v[52:55], v[48:51], v[108:111], v[52:55]
    v_mfma_f32_16x16x32_bf16 v[56:59], v[108:111], v[108:111], v[56:59]
    v_mfma_f32_16x16x32_bf16 v[52:55], v[48:51], v[112:115], v[52:55]
    v_mfma_f32_16x16x32_bf16 v[56:59], v[112:115], v[112:115], v[56:59]
    v_mfma_f32_16x16x32_bf16 v[52:55], v[48:51], v[116:119], v[52:55]
    v_mfma_f32_16x16x32_bf16 v[56:59], v[116:119], v[116:119], v[56:59]
    v_mfma_f32_16x16x32_bf16 v[52:55], v[48:51], v[120:123], v[52:55]
    v_mfma_f32_16x16x32_bf16 v[56:59], v[120:123], v[120:123], v[56:59]
    v_mfma_f32_16x16x32_bf16 v[52:55], v[48:51], v[124:127], v[52:55]
    v_mfma_f32_16x16x32_bf16 v[56:59], v[124:127], v[124:127], v[56:59]
    v_mfma_f32_16x16x32_bf16 v[52:55], v[48:51], v[128:131], v[52:55]
    v_mfma_f32_16x16x32_bf16 v[56:59], v[128:131], v[128:131], v[56:59]
    v_mfma_f32_16x16x32_bf16 v[52:55], v[48:51], v[132:135], v[52:55]
    v_mfma_f32_16x16x32_bf16 v[56:59], v[132:135], v[132:135], v[56:59]
    v_mfma_f32_16x16x32_bf16 v[52:55], v[48:51], v[136:139], v[52:55]
    v_mfma_f32_16x16x32_bf16 v[56:59], v[136:139], v[136:139], v[56:59]
    v_lshlrev_b32 v60, 2, v3
    v_sub_u32 v60, v2, v60
    s_nop 4
    v_mov_b32 v61, 0
    v_cmp_eq_u32 vcc, 0, v60
    s_nop 1
    v_cndmask_b32 v61, v61, v56, vcc
    v_cmp_eq_u32 vcc, 1, v60
    s_nop 1
    v_cndmask_b32 v61, v61, v57, vcc
    v_cmp_eq_u32 vcc, 2, v60
    s_nop 1
    v_cndmask_b32 v61, v61, v58, vcc
    v_cmp_eq_u32 vcc, 3, v60
    s_nop 1
    v_cndmask_b32 v61, v61, v59, vcc
    v_mov_b32 v57, v61
    v_mov_b32 v56, v52
    v_mov_b32 v58, v57
    s_nop 1
    v_permlane32_swap_b32 v57, v58
    v_add_f32 v57, v57, v58
    v_mov_b32 v58, v57
    s_nop 1
    v_permlane16_swap_b32 v57, v58
    v_add_f32 v57, v57, v58
    s_lshl_b32 s27, s74, 7
    s_add_u32 s27, s27, 137216
    v_lshl_add_u32 v7, v2, 3, s27
    ds_write_b64 v7, v[56:57]
    s_xor_b32 s28, s74, 4
    s_lshl_b32 s28, s28, 7
    s_add_u32 s28, s28, 137216
    v_lshl_add_u32 v7, v2, 3, s28
    s_waitcnt lgkmcnt(0)
    s_barrier
    ds_read_b64 v[58:59], v7
    s_waitcnt lgkmcnt(0)
    v_add_f32 v56, v56, v58
    v_add_f32 v57, v57, v59
    v_mul_f32 v56, 0x3acccccd, v56
    v_mul_f32 v57, 0x3acccccd, v57
    v_fma_f32 v57, -v56, v56, v57
    v_add_f32 v57, 0x3727c5ac, v57
    v_rsq_f32 v57, v57
    s_nop 0
    v_mul_f32 v56, v56, v57
    v_sub_f32 v56, 0, v56
    v_lshlrev_b32 v140, 16, v100
    v_and_b32 v141, 0xffff0000, v100
    v_lshlrev_b32 v142, 16, v101
    v_and_b32 v143, 0xffff0000, v101
    v_lshlrev_b32 v144, 16, v102
    v_and_b32 v145, 0xffff0000, v102
    v_lshlrev_b32 v146, 16, v103
    v_and_b32 v147, 0xffff0000, v103
    v_lshlrev_b32 v148, 16, v104
    v_and_b32 v149, 0xffff0000, v104
    v_lshlrev_b32 v150, 16, v105
    v_and_b32 v151, 0xffff0000, v105
    v_lshlrev_b32 v152, 16, v106
    v_and_b32 v153, 0xffff0000, v106
    v_lshlrev_b32 v154, 16, v107
    v_and_b32 v155, 0xffff0000, v107
    v_lshlrev_b32 v156, 16, v108
    v_and_b32 v157, 0xffff0000, v108
    v_lshlrev_b32 v158, 16, v109
    v_and_b32 v159, 0xffff0000, v109
    v_lshlrev_b32 v160, 16, v110
    v_and_b32 v161, 0xffff0000, v110
    v_lshlrev_b32 v162, 16, v111
    v_and_b32 v163, 0xffff0000, v111
    v_lshlrev_b32 v164, 16, v112
    v_and_b32 v165, 0xffff0000, v112
    v_lshlrev_b32 v166, 16, v113
    v_and_b32 v167, 0xffff0000, v113
    v_lshlrev_b32 v168, 16, v114
    v_and_b32 v169, 0xffff0000, v114
    v_lshlrev_b32 v170, 16, v115
    v_and_b32 v171, 0xffff0000, v115
    v_lshlrev_b32 v172, 16, v116
    v_and_b32 v173, 0xffff0000, v116
    v_lshlrev_b32 v174, 16, v117
    v_and_b32 v175, 0xffff0000, v117
    v_lshlrev_b32 v176, 16, v118
    v_and_b32 v177, 0xffff0000, v118
    v_lshlrev_b32 v178, 16, v119
    v_and_b32 v179, 0xffff0000, v119
    v_lshlrev_b32 v180, 16, v120
    v_and_b32 v181, 0xffff0000, v120
    v_lshlrev_b32 v182, 16, v121
    v_and_b32 v183, 0xffff0000, v121
    v_lshlrev_b32 v184, 16, v122
    v_and_b32 v185, 0xffff0000, v122
    v_lshlrev_b32 v186, 16, v123
    v_and_b32 v187, 0xffff0000, v123
    v_lshlrev_b32 v188, 16, v124
    v_and_b32 v189, 0xffff0000, v124
    v_lshlrev_b32 v190, 16, v125
    v_and_b32 v191, 0xffff0000, v125
    v_lshlrev_b32 v192, 16, v126
    v_and_b32 v193, 0xffff0000, v126
    v_lshlrev_b32 v194, 16, v127
    v_and_b32 v195, 0xffff0000, v127
    v_lshlrev_b32 v196, 16, v128
    v_and_b32 v197, 0xffff0000, v128
    v_lshlrev_b32 v198, 16, v129
    v_and_b32 v199, 0xffff0000, v129
    v_lshlrev_b32 v200, 16, v130
    v_and_b32 v201, 0xffff0000, v130
    v_lshlrev_b32 v202, 16, v131
    v_and_b32 v203, 0xffff0000, v131
    v_lshlrev_b32 v204, 16, v132
    v_and_b32 v205, 0xffff0000, v132
    v_lshlrev_b32 v206, 16, v133
    v_and_b32 v207, 0xffff0000, v133
    v_lshlrev_b32 v208, 16, v134
    v_and_b32 v209, 0xffff0000, v134
    v_lshlrev_b32 v210, 16, v135
    v_and_b32 v211, 0xffff0000, v135
    v_lshlrev_b32 v212, 16, v136
    v_and_b32 v213, 0xffff0000, v136
    v_lshlrev_b32 v214, 16, v137
    v_and_b32 v215, 0xffff0000, v137
    v_lshlrev_b32 v216, 16, v138
    v_and_b32 v217, 0xffff0000, v138
    v_lshlrev_b32 v218, 16, v139
    v_and_b32 v219, 0xffff0000, v139
    v_pk_fma_f32 v[140:141], v[140:141], v[56:57], v[56:57] op_sel:[0,1,0] op_sel_hi:[1,1,0]
    v_pk_fma_f32 v[142:143], v[142:143], v[56:57], v[56:57] op_sel:[0,1,0] op_sel_hi:[1,1,0]
    v_pk_fma_f32 v[144:145], v[144:145], v[56:57], v[56:57] op_sel:[0,1,0] op_sel_hi:[1,1,0]
    v_pk_fma_f32 v[146:147], v[146:147], v[56:57], v[56:57] op_sel:[0,1,0] op_sel_hi:[1,1,0]
    v_pk_fma_f32 v[148:149], v[148:149], v[56:57], v[56:57] op_sel:[0,1,0] op_sel_hi:[1,1,0]
    v_pk_fma_f32 v[150:151], v[150:151], v[56:57], v[56:57] op_sel:[0,1,0] op_sel_hi:[1,1,0]
    v_pk_fma_f32 v[152:153], v[152:153], v[56:57], v[56:57] op_sel:[0,1,0] op_sel_hi:[1,1,0]
    v_pk_fma_f32 v[154:155], v[154:155], v[56:57], v[56:57] op_sel:[0,1,0] op_sel_hi:[1,1,0]
    v_pk_fma_f32 v[156:157], v[156:157], v[56:57], v[56:57] op_sel:[0,1,0] op_sel_hi:[1,1,0]
    v_pk_fma_f32 v[158:159], v[158:159], v[56:57], v[56:57] op_sel:[0,1,0] op_sel_hi:[1,1,0]
    v_pk_fma_f32 v[160:161], v[160:161], v[56:57], v[56:57] op_sel:[0,1,0] op_sel_hi:[1,1,0]
    v_pk_fma_f32 v[162:163], v[162:163], v[56:57], v[56:57] op_sel:[0,1,0] op_sel_hi:[1,1,0]
    v_pk_fma_f32 v[164:165], v[164:165], v[56:57], v[56:57] op_sel:[0,1,0] op_sel_hi:[1,1,0]
    v_pk_fma_f32 v[166:167], v[166:167], v[56:57], v[56:57] op_sel:[0,1,0] op_sel_hi:[1,1,0]
    v_pk_fma_f32 v[168:169], v[168:169], v[56:57], v[56:57] op_sel:[0,1,0] op_sel_hi:[1,1,0]
    v_pk_fma_f32 v[170:171], v[170:171], v[56:57], v[56:57] op_sel:[0,1,0] op_sel_hi:[1,1,0]
    v_pk_fma_f32 v[172:173], v[172:173], v[56:57], v[56:57] op_sel:[0,1,0] op_sel_hi:[1,1,0]
    v_pk_fma_f32 v[174:175], v[174:175], v[56:57], v[56:57] op_sel:[0,1,0] op_sel_hi:[1,1,0]
    v_pk_fma_f32 v[176:177], v[176:177], v[56:57], v[56:57] op_sel:[0,1,0] op_sel_hi:[1,1,0]
    v_pk_fma_f32 v[178:179], v[178:179], v[56:57], v[56:57] op_sel:[0,1,0] op_sel_hi:[1,1,0]
    v_pk_fma_f32 v[180:181], v[180:181], v[56:57], v[56:57] op_sel:[0,1,0] op_sel_hi:[1,1,0]
    v_pk_fma_f32 v[182:183], v[182:183], v[56:57], v[56:57] op_sel:[0,1,0] op_sel_hi:[1,1,0]
    v_pk_fma_f32 v[184:185], v[184:185], v[56:57], v[56:57] op_sel:[0,1,0] op_sel_hi:[1,1,0]
    v_pk_fma_f32 v[186:187], v[186:187], v[56:57], v[56:57] op_sel:[0,1,0] op_sel_hi:[1,1,0]
    v_pk_fma_f32 v[188:189], v[188:189], v[56:57], v[56:57] op_sel:[0,1,0] op_sel_hi:[1,1,0]
    v_pk_fma_f32 v[190:191], v[190:191], v[56:57], v[56:57] op_sel:[0,1,0] op_sel_hi:[1,1,0]
    v_pk_fma_f32 v[192:193], v[192:193], v[56:57], v[56:57] op_sel:[0,1,0] op_sel_hi:[1,1,0]
    v_pk_fma_f32 v[194:195], v[194:195], v[56:57], v[56:57] op_sel:[0,1,0] op_sel_hi:[1,1,0]
    v_pk_fma_f32 v[196:197], v[196:197], v[56:57], v[56:57] op_sel:[0,1,0] op_sel_hi:[1,1,0]
    v_pk_fma_f32 v[198:199], v[198:199], v[56:57], v[56:57] op_sel:[0,1,0] op_sel_hi:[1,1,0]
    v_pk_fma_f32 v[200:201], v[200:201], v[56:57], v[56:57] op_sel:[0,1,0] op_sel_hi:[1,1,0]
    v_pk_fma_f32 v[202:203], v[202:203], v[56:57], v[56:57] op_sel:[0,1,0] op_sel_hi:[1,1,0]
    v_pk_fma_f32 v[204:205], v[204:205], v[56:57], v[56:57] op_sel:[0,1,0] op_sel_hi:[1,1,0]
    v_pk_fma_f32 v[206:207], v[206:207], v[56:57], v[56:57] op_sel:[0,1,0] op_sel_hi:[1,1,0]
    v_pk_fma_f32 v[208:209], v[208:209], v[56:57], v[56:57] op_sel:[0,1,0] op_sel_hi:[1,1,0]
    v_pk_fma_f32 v[210:211], v[210:211], v[56:57], v[56:57] op_sel:[0,1,0] op_sel_hi:[1,1,0]
    v_pk_fma_f32 v[212:213], v[212:213], v[56:57], v[56:57] op_sel:[0,1,0] op_sel_hi:[1,1,0]
    v_pk_fma_f32 v[214:215], v[214:215], v[56:57], v[56:57] op_sel:[0,1,0] op_sel_hi:[1,1,0]
    v_pk_fma_f32 v[216:217], v[216:217], v[56:57], v[56:57] op_sel:[0,1,0] op_sel_hi:[1,1,0]
    v_pk_fma_f32 v[218:219], v[218:219], v[56:57], v[56:57] op_sel:[0,1,0] op_sel_hi:[1,1,0]
    s_cmp_ge_u32 s74, 5
    s_cbranch_scc1 L_f_mp
    v_lshlrev_b32 v7, 4, v0
    s_mov_b32 s28, 31784960
    s_mov_b32 s101, 0x40000
L_pg_8:
    buffer_load_dwordx4 v[8:11], v7, s[8:11], s28 offen sc1
    s_waitcnt vmcnt(0)
    v_cmp_ne_u32 vcc, s79, v9
    v_cmp_ne_u32 s[26:27], s79, v11
    s_or_b64 vcc, vcc, s[26:27]
    s_sub_u32 s101, s101, 1
    s_cmp_eq_u64 vcc, 0
    s_cbranch_scc1 L_pgd_9
    s_sleep 4
    s_cmp_lg_u32 s101, 0
    s_cbranch_scc1 L_pg_8
L_pgd_9:
    s_mov_b32 s28, 31790080
    s_mov_b32 s101, 0x40000
L_pg_10:
    buffer_load_dwordx4 v[12:15], v7, s[8:11], s28 offen sc1
    s_waitcnt vmcnt(0)
    v_cmp_ne_u32 vcc, s79, v13
    v_cmp_ne_u32 s[26:27], s79, v15
    s_or_b64 vcc, vcc, s[26:27]
    s_sub_u32 s101, s101, 1
    s_cmp_eq_u64 vcc, 0
    s_cbranch_scc1 L_pgd_11
    s_sleep 4
    s_cmp_lg_u32 s101, 0
    s_cbranch_scc1 L_pg_10
L_pgd_11:
    v_add_f32 v12, 1.0, v12
    v_add_f32 v14, 1.0, v14
    v_cvt_pk_bf16_f32 v12, v12, v14
    v_and_b32 v13, 0xffff0000, v12
    v_lshlrev_b32 v12, 16, v12
    v_mov_b32 v9, v10
    v_lshlrev_b32 v7, 3, v0
    v_add_u32 v7, 76800, v7
    ds_write_b64 v7, v[12:13]
    ds_write_b64 v7, v[8:9] offset:2560
L_f_mp:
    s_waitcnt vmcnt(0) lgkmcnt(0)
    s_barrier
    v_mov_b32 v64, 0
    v_mov_b32 v65, 0
    v_mov_b32 v66, 0
    v_mov_b32 v67, 0
    v_mov_b32 v68, 0
    v_mov_b32 v69, 0
    v_mov_b32 v70, 0
    v_mov_b32 v71, 0
    v_mov_b32 v72, 0
    v_mov_b32 v73, 0
    v_mov_b32 v74, 0
    v_mov_b32 v75, 0
    v_mov_b32 v76, 0
    v_mov_b32 v77, 0
    v_mov_b32 v78, 0
    v_mov_b32 v79, 0
    v_mov_b32 v80, 0
    v_mov_b32 v81, 0
    v_mov_b32 v82, 0
    v_mov_b32 v83, 0
    v_mov_b32 v84, 0
    v_mov_b32 v85, 0
    v_mov_b32 v86, 0
    v_mov_b32 v87, 0
    v_mov_b32 v88, 0
    v_mov_b32 v89, 0
    v_mov_b32 v90, 0
    v_mov_b32 v91, 0
    v_lshrrev_b32 v6, 2, v2
    v_lshl_add_u32 v6, v3, 2, v6
    v_and_b32 v7, 3, v2
    v_and_b32 v92, 1, v7
    v_mul_u32_u24 v92, 40, v92
    v_lshrrev_b32 v93, 1, v7
    v_lshl_add_u32 v92, v93, 4, v92
    v_mul_u32_u24 v93, 40, v7
    v_add_u32 v93, 32, v93
    v_mul_u32_u24 v94, 160, v6
    s_mul_i32 s24, s76, 25600
    v_add_u32 v94, s24, v94
    v_add_u32 v92, v92, v94
    v_add_u32 v93, v93, v94
    v_add_u32 v96, 81920, v92
    v_add_u32 v97, 81920, v93
    v_mul_u32_u24 v94, 40, v6
    v_lshl_add_u32 v94, v7, 3, v94
    s_mul_i32 s24, s76, 6400
    s_add_u32 s24, s24, 51200
    v_add_u32 v94, s24, v94
    s_mul_i32 s24, s76, 640
    s_add_u32 s24, s24, 76800
    v_lshl_add_u32 v95, v3, 4, s24
    s_cmp_lt_u32 s73, 2
    s_cselect_b32 s35, 1, 0
    s_cmp_eq_u32 s73, 1
    s_cselect_b32 s36, 1, 0
    s_mov_b32 s38, 0
    ds_read_b128 v[48:51], v95 offset:0
    ds_read_b128 v[52:55], v95 offset:64
    ds_read_b128 v[56:59], v95 offset:2560
    ds_read_b128 v[60:63], v95 offset:2624
    ds_read_b128 v[220:223], v95 offset:128
    ds_read_b128 v[224:227], v95 offset:192
    ds_read_b128 v[228:231], v95 offset:2688
    ds_read_b128 v[232:235], v95 offset:2752
    s_waitcnt lgkmcnt(4)
    v_pk_fma_f32 v[140:141], v[140:141], v[48:49], v[56:57]
    v_pk_fma_f32 v[142:143], v[142:143], v[50:51], v[58:59]
    v_pk_fma_f32 v[144:145], v[144:145], v[52:53], v[60:61]
    v_pk_fma_f32 v[146:147], v[146:147], v[54:55], v[62:63]
    v_cvt_pk_bf16_f32 v100, v140, v141
    v_cvt_pk_bf16_f32 v101, v142, v143
    v_cvt_pk_bf16_f32 v102, v144, v145
    v_cvt_pk_bf16_f32 v103, v146, v147
    ds_read_b128 v[48:51], v95 offset:256
    ds_read_b128 v[52:55], v95 offset:320
    ds_read_b128 v[56:59], v95 offset:2816
    ds_read_b128 v[60:63], v95 offset:2880
    s_waitcnt lgkmcnt(4)
    v_pk_fma_f32 v[148:149], v[148:149], v[220:221], v[228:229]
    v_pk_fma_f32 v[150:151], v[150:151], v[222:223], v[230:231]
    v_pk_fma_f32 v[152:153], v[152:153], v[224:225], v[232:233]
    v_pk_fma_f32 v[154:155], v[154:155], v[226:227], v[234:235]
    v_cvt_pk_bf16_f32 v104, v148, v149
    v_cvt_pk_bf16_f32 v105, v150, v151
    v_cvt_pk_bf16_f32 v106, v152, v153
    v_cvt_pk_bf16_f32 v107, v154, v155
    ds_read_b128 v[220:223], v95 offset:384
    ds_read_b128 v[224:227], v95 offset:448
    ds_read_b128 v[228:231], v95 offset:2944
    ds_read_b128 v[232:235], v95 offset:3008
    s_waitcnt lgkmcnt(4)
    v_pk_fma_f32 v[156:157], v[156:157], v[48:49], v[56:57]
    v_pk_fma_f32 v[158:159], v[158:159], v[50:51], v[58:59]
    v_pk_fma_f32 v[160:161], v[160:161], v[52:53], v[60:61]
    v_pk_fma_f32 v[162:163], v[162:163], v[54:55], v[62:63]
    v_cvt_pk_bf16_f32 v108, v156, v157
    v_cvt_pk_bf16_f32 v109, v158, v159
    v_cvt_pk_bf16_f32 v110, v160, v161
    v_cvt_pk_bf16_f32 v111, v162, v163
    ds_read_b128 v[48:51], v95 offset:512
    ds_read_b128 v[52:55], v95 offset:576
    ds_read_b128 v[56:59], v95 offset:3072
    ds_read_b128 v[60:63], v95 offset:3136
    s_waitcnt lgkmcnt(4)
    v_pk_fma_f32 v[164:165], v[164:165], v[220:221], v[228:229]
    v_pk_fma_f32 v[166:167], v[166:167], v[222:223], v[230:231]
    v_pk_fma_f32 v[168:169], v[168:169], v[224:225], v[232:233]
    v_pk_fma_f32 v[170:171], v[170:171], v[226:227], v[234:235]
    v_cvt_pk_bf16_f32 v112, v164, v165
    v_cvt_pk_bf16_f32 v113, v166, v167
    v_cvt_pk_bf16_f32 v114, v168, v169
    v_cvt_pk_bf16_f32 v115, v170, v171
    ds_read_b128 v[220:223], v95 offset:1280
    ds_read_b128 v[224:227], v95 offset:1344
    ds_read_b128 v[228:231], v95 offset:3840
    ds_read_b128 v[232:235], v95 offset:3904
    s_waitcnt lgkmcnt(4)
    v_pk_fma_f32 v[172:173], v[172:173], v[48:49], v[56:57]
    v_pk_fma_f32 v[174:175], v[174:175], v[50:51], v[58:59]
    v_pk_fma_f32 v[176:177], v[176:177], v[52:53], v[60:61]
    v_pk_fma_f32 v[178:179], v[178:179], v[54:55], v[62:63]
    v_cvt_pk_bf16_f32 v116, v172, v173
    v_cvt_pk_bf16_f32 v117, v174, v175
    v_cvt_pk_bf16_f32 v118, v176, v177
    v_cvt_pk_bf16_f32 v119, v178, v179
    ds_read_b128 v[48:51], v95 offset:1408
    ds_read_b128 v[52:55], v95 offset:1472
    ds_read_b128 v[56:59], v95 offset:3968
    ds_read_b128 v[60:63], v95 offset:4032
    s_waitcnt lgkmcnt(4)
    v_pk_fma_f32 v[180:181], v[180:181], v[220:221], v[228:229]
    v_pk_fma_f32 v[182:183], v[182:183], v[222:223], v[230:231]
    v_pk_fma_f32 v[184:185], v[184:185], v[224:225], v[232:233]
    v_pk_fma_f32 v[186:187], v[186:187], v[226:227], v[234:235]
    v_cvt_pk_bf16_f32 v120, v180, v181
    v_cvt_pk_bf16_f32 v121, v182, v183
    v_cvt_pk_bf16_f32 v122, v184, v185
    v_cvt_pk_bf16_f32 v123, v186, v187
    ds_read_b128 v[220:223], v95 offset:1536
    ds_read_b128 v[224:227], v95 offset:1600
    ds_read_b128 v[228:231], v95 offset:4096
    ds_read_b128 v[232:235], v95 offset:4160
    s_waitcnt lgkmcnt(4)
    v_pk_fma_f32 v[188:189], v[188:189], v[48:49], v[56:57]
    v_pk_fma_f32 v[190:191], v[190:191], v[50:51], v[58:59]
    v_pk_fma_f32 v[192:193], v[192:193], v[52:53], v[60:61]
    v_pk_fma_f32 v[194:195], v[194:195], v[54:55], v[62:63]
    v_cvt_pk_bf16_f32 v124, v188, v189
    v_cvt_pk_bf16_f32 v125, v190, v191
    v_cvt_pk_bf16_f32 v126, v192, v193
    v_cvt_pk_bf16_f32 v127, v194, v195
    ds_read_b128 v[48:51], v95 offset:1664
    ds_read_b128 v[52:55], v95 offset:1728
    ds_read_b128 v[56:59], v95 offset:4224
    ds_read_b128 v[60:63], v95 offset:4288
    s_waitcnt lgkmcnt(4)
    v_pk_fma_f32 v[196:197], v[196:197], v[220:221], v[228:229]
    v_pk_fma_f32 v[198:199], v[198:199], v[222:223], v[230:231]
    v_pk_fma_f32 v[200:201], v[200:201], v[224:225], v[232:233]
    v_pk_fma_f32 v[202:203], v[202:203], v[226:227], v[234:235]
    v_cvt_pk_bf16_f32 v128, v196, v197
    v_cvt_pk_bf16_f32 v129, v198, v199
    v_cvt_pk_bf16_f32 v130, v200, v201
    v_cvt_pk_bf16_f32 v131, v202, v203
    ds_read_b128 v[220:223], v95 offset:1792
    ds_read_b128 v[224:227], v95 offset:1856
    ds_read_b128 v[228:231], v95 offset:4352
    ds_read_b128 v[232:235], v95 offset:4416
    s_waitcnt lgkmcnt(4)
    v_pk_fma_f32 v[204:205], v[204:205], v[48:49], v[56:57]
    v_pk_fma_f32 v[206:207], v[206:207], v[50:51], v[58:59]
    v_pk_fma_f32 v[208:209], v[208:209], v[52:53], v[60:61]
    v_pk_fma_f32 v[210:211], v[210:211], v[54:55], v[62:63]
    v_cvt_pk_bf16_f32 v132, v204, v205
    v_cvt_pk_bf16_f32 v133, v206, v207
    v_cvt_pk_bf16_f32 v134, v208, v209
    v_cvt_pk_bf16_f32 v135, v210, v211
    s_waitcnt lgkmcnt(0)
    v_pk_fma_f32 v[212:213], v[212:213], v[220:221], v[228:229]
    v_pk_fma_f32 v[214:215], v[214:215], v[222:223], v[230:231]
    v_pk_fma_f32 v[216:217], v[216:217], v[224:225], v[232:233]
    v_pk_fma_f32 v[218:219], v[218:219], v[226:227], v[234:235]
    v_cvt_pk_bf16_f32 v136, v212, v213
    v_cvt_pk_bf16_f32 v137, v214, v215
    v_cvt_pk_bf16_f32 v138, v216, v217
    v_cvt_pk_bf16_f32 v139, v218, v219
    s_sub_u32 s24, s74, 4
    s_cmp_lt_u32 s24, 2
    s_cbranch_scc1 L_f_q3
    s_mov_b32 s24, s74
    s_cmp_lt_u32 s74, 4
    s_cbranch_scc1 L_f_q5
    s_sub_u32 s24, s74, 2
    s_mul_i32 s25, s24, 40960
    s_add_u32 s25, s25, s34
    s_add_u32 s25, s25, 409600
    s_mul_i32 s26, s24, 5120
    s_add_u32 s26, s26, 0
    s_add_u32 m0, s26, 0
    s_nop 0
    buffer_load_dwordx4 v240, s[12:15], s25 offen lds
    s_add_u32 m0, s26, 1024
    s_nop 0
    buffer_load_dwordx4 v241, s[12:15], s25 offen lds
    s_add_u32 m0, s26, 2048
    s_nop 0
    buffer_load_dwordx4 v242, s[12:15], s25 offen lds
    s_add_u32 m0, s26, 3072
    s_nop 0
    buffer_load_dwordx4 v243, s[12:15], s25 offen lds
    s_add_u32 m0, s26, 4096
    s_nop 0
    buffer_load_dwordx4 v244, s[12:15], s25 offen lds
    s_branch L_f_q3
L_f_q5:
    s_mul_i32 s25, s24, 40960
    s_add_u32 s25, s25, s34
    s_add_u32 s25, s25, 409600
    s_mul_i32 s26, s24, 5120
    s_add_u32 s26, s26, 0
    s_add_u32 m0, s26, 0
    s_nop 0
    buffer_load_dwordx4 v240, s[12:15], s25 offen lds
    s_add_u32 m0, s26, 1024
    s_nop 0
    buffer_load_dwordx4 v241, s[12:15], s25 offen lds
    s_add_u32 m0, s26, 2048
    s_nop 0
    buffer_load_dwordx4 v242, s[12:15], s25 offen lds
    s_add_u32 m0, s26, 3072
    s_nop 0
    buffer_load_dwordx4 v243, s[12:15], s25 offen lds
    s_add_u32 m0, s26, 4096
    s_nop 0
    buffer_load_dwordx4 v244, s[12:15], s25 offen lds
    s_add_u32 s24, s74, 6
    s_mul_i32 s25, s24, 40960
    s_add_u32 s25, s25, s34
    s_add_u32 s25, s25, 409600
    s_mul_i32 s26, s24, 5120
    s_add_u32 s26, s26, 0
    s_add_u32 m0, s26, 0
    s_nop 0
    buffer_load_dwordx4 v240, s[12:15], s25 offen lds
    s_add_u32 m0, s26, 1024
    s_nop 0
    buffer_load_dwordx4 v241, s[12:15], s25 offen lds
    s_add_u32 m0, s26, 2048
    s_nop 0
    buffer_load_dwordx4 v242, s[12:15], s25 offen lds
    s_add_u32 m0, s26, 3072
    s_nop 0
    buffer_load_dwordx4 v243, s[12:15], s25 offen lds
    s_add_u32 m0, s26, 4096
    s_nop 0
    buffer_load_dwordx4 v244, s[12:15], s25 offen lds
L_f_q3:
    s_cmp_ge_u32 s73, 2
    s_cbranch_scc1 L_f_kvd
    ds_read_b64_tr_b16 v[140:141], v94 offset:0
    ds_read_b64_tr_b16 v[142:143], v94 offset:640
    ds_read_b64_tr_b16 v[144:145], v94 offset:32
    ds_read_b64_tr_b16 v[146:147], v94 offset:672
    ds_read_b64_tr_b16 v[148:149], v94 offset:1280
    ds_read_b64_tr_b16 v[150:151], v94 offset:1920
    ds_read_b64_tr_b16 v[152:153], v94 offset:1312
    ds_read_b64_tr_b16 v[154:155], v94 offset:1952
    ds_read_b64_tr_b16 v[156:157], v94 offset:2560
    ds_read_b64_tr_b16 v[158:159], v94 offset:3200
    ds_read_b64_tr_b16 v[160:161], v94 offset:2592
    ds_read_b64_tr_b16 v[162:163], v94 offset:3232
    s_waitcnt lgkmcnt(4)
    ds_read_b64_tr_b16 v[164:165], v94 offset:3840
    ds_read_b64_tr_b16 v[166:167], v94 offset:4480
    ds_read_b64_tr_b16 v[168:169], v94 offset:3872
    ds_read_b64_tr_b16 v[170:171], v94 offset:4512
    ds_read_b64_tr_b16 v[172:173], v94 offset:5120
    ds_read_b64_tr_b16 v[174:175], v94 offset:5760
    ds_read_b64_tr_b16 v[176:177], v94 offset:5152
    ds_read_b64_tr_b16 v[178:179], v94 offset:5792
    s_waitcnt lgkmcnt(0)
    s_cmp_eq_u32 s36, 1
    s_cbranch_scc1 L_f_kv_12
    v_mfma_f32_16x16x32_bf16 v[84:87], v[140:143], v[100:103], v[84:87]
    v_mfma_f32_16x16x32_bf16 v[88:91], v[144:147], v[100:103], v[88:91]
    v_mfma_f32_16x16x32_bf16 v[84:87], v[148:151], v[104:107], v[84:87]
    v_mfma_f32_16x16x32_bf16 v[88:91], v[152:155], v[104:107], v[88:91]
    v_mfma_f32_16x16x32_bf16 v[84:87], v[156:159], v[108:111], v[84:87]
    v_mfma_f32_16x16x32_bf16 v[88:91], v[160:163], v[108:111], v[88:91]
    v_mfma_f32_16x16x32_bf16 v[84:87], v[164:167], v[112:115], v[84:87]
    v_mfma_f32_16x16x32_bf16 v[88:91], v[168:171], v[112:115], v[88:91]
    v_mfma_f32_16x16x32_bf16 v[84:87], v[172:175], v[116:119], v[84:87]
    v_mfma_f32_16x16x32_bf16 v[88:91], v[176:179], v[116:119], v[88:91]
    s_branch L_f_kv_13
L_f_kv_12:
    v_mfma_f32_16x16x32_bf16 v[84:87], v[100:103], v[140:143], v[84:87]
    v_mfma_f32_16x16x32_bf16 v[88:91], v[100:103], v[144:147], v[88:91]
    v_mfma_f32_16x16x32_bf16 v[84:87], v[104:107], v[148:151], v[84:87]
    v_mfma_f32_16x16x32_bf16 v[88:91], v[104:107], v[152:155], v[88:91]
    v_mfma_f32_16x16x32_bf16 v[84:87], v[108:111], v[156:159], v[84:87]
    v_mfma_f32_16x16x32_bf16 v[88:91], v[108:111], v[160:163], v[88:91]
    v_mfma_f32_16x16x32_bf16 v[84:87], v[112:115], v[164:167], v[84:87]
    v_mfma_f32_16x16x32_bf16 v[88:91], v[112:115], v[168:171], v[88:91]
    v_mfma_f32_16x16x32_bf16 v[84:87], v[116:119], v[172:175], v[84:87]
    v_mfma_f32_16x16x32_bf16 v[88:91], v[116:119], v[176:179], v[88:91]
L_f_kv_13:
    ds_read_b64_tr_b16 v[140:141], v94 offset:12800
    ds_read_b64_tr_b16 v[142:143], v94 offset:13440
    ds_read_b64_tr_b16 v[144:145], v94 offset:12832
    ds_read_b64_tr_b16 v[146:147], v94 offset:13472
    ds_read_b64_tr_b16 v[148:149], v94 offset:14080
    ds_read_b64_tr_b16 v[150:151], v94 offset:14720
    ds_read_b64_tr_b16 v[152:153], v94 offset:14112
    ds_read_b64_tr_b16 v[154:155], v94 offset:14752
    ds_read_b64_tr_b16 v[156:157], v94 offset:15360
    ds_read_b64_tr_b16 v[158:159], v94 offset:16000
    ds_read_b64_tr_b16 v[160:161], v94 offset:15392
    ds_read_b64_tr_b16 v[162:163], v94 offset:16032
    s_waitcnt lgkmcnt(4)
    ds_read_b64_tr_b16 v[164:165], v94 offset:16640
    ds_read_b64_tr_b16 v[166:167], v94 offset:17280
    ds_read_b64_tr_b16 v[168:169], v94 offset:16672
    ds_read_b64_tr_b16 v[170:171], v94 offset:17312
    ds_read_b64_tr_b16 v[172:173], v94 offset:17920
    ds_read_b64_tr_b16 v[174:175], v94 offset:18560
    ds_read_b64_tr_b16 v[176:177], v94 offset:17952
    ds_read_b64_tr_b16 v[178:179], v94 offset:18592
    s_waitcnt lgkmcnt(0)
    s_cmp_eq_u32 s36, 1
    s_cbranch_scc1 L_f_kv_14
    v_mfma_f32_16x16x32_bf16 v[84:87], v[140:143], v[120:123], v[84:87]
    v_mfma_f32_16x16x32_bf16 v[88:91], v[144:147], v[120:123], v[88:91]
    v_mfma_f32_16x16x32_bf16 v[84:87], v[148:151], v[124:127], v[84:87]
    v_mfma_f32_16x16x32_bf16 v[88:91], v[152:155], v[124:127], v[88:91]
    v_mfma_f32_16x16x32_bf16 v[84:87], v[156:159], v[128:131], v[84:87]
    v_mfma_f32_16x16x32_bf16 v[88:91], v[160:163], v[128:131], v[88:91]
    v_mfma_f32_16x16x32_bf16 v[84:87], v[164:167], v[132:135], v[84:87]
    v_mfma_f32_16x16x32_bf16 v[88:91], v[168:171], v[132:135], v[88:91]
    v_mfma_f32_16x16x32_bf16 v[84:87], v[172:175], v[136:139], v[84:87]
    v_mfma_f32_16x16x32_bf16 v[88:91], v[176:179], v[136:139], v[88:91]
    s_branch L_f_kv_15
L_f_kv_14:
    v_mfma_f32_16x16x32_bf16 v[84:87], v[120:123], v[140:143], v[84:87]
    v_mfma_f32_16x16x32_bf16 v[88:91], v[120:123], v[144:147], v[88:91]
    v_mfma_f32_16x16x32_bf16 v[84:87], v[124:127], v[148:151], v[84:87]
    v_mfma_f32_16x16x32_bf16 v[88:91], v[124:127], v[152:155], v[88:91]
    v_mfma_f32_16x16x32_bf16 v[84:87], v[128:131], v[156:159], v[84:87]
    v_mfma_f32_16x16x32_bf16 v[88:91], v[128:131], v[160:163], v[88:91]
    v_mfma_f32_16x16x32_bf16 v[84:87], v[132:135], v[164:167], v[84:87]
    v_mfma_f32_16x16x32_bf16 v[88:91], v[132:135], v[168:171], v[88:91]
    v_mfma_f32_16x16x32_bf16 v[84:87], v[136:139], v[172:175], v[84:87]
    v_mfma_f32_16x16x32_bf16 v[88:91], v[136:139], v[176:179], v[88:91]
L_f_kv_15:
    s_lshl_b32 s24, s75, 11
    s_add_u32 s24, s24, 143360
    v_lshl_add_u32 v6, v1, 4, s24
    s_cmp_eq_u32 s76, 0
    s_cbranch_scc1 L_f_kx
    s_nop 4
    ds_write_b128 v6, v[84:87]
    ds_write_b128 v6, v[88:91] offset:1024
    s_waitcnt lgkmcnt(0)
L_f_kx:
    s_barrier
    s_cmp_eq_u32 s76, 0
    s_cbranch_scc0 L_f_kvb
    ds_read_b128 v[28:31], v6
    ds_read_b128 v[32:35], v6 offset:1024
    s_lshr_b32 s24, s75, 1
    s_lshl_b32 s24, s24, 11
    s_add_u32 s24, s24, 151552
    s_and_b32 s25, s75, 1
    v_mov_b32 v36, 0x3f803f80
    v_mov_b32 v37, 0x00003f80
    s_waitcnt lgkmcnt(0)
    v_add_f32 v84, v84, v28
    v_add_f32 v88, v88, v32
    v_add_f32 v85, v85, v29
    v_add_f32 v89, v89, v33
    v_add_f32 v86, v86, v30
    v_add_f32 v90, v90, v34
    v_add_f32 v87, v87, v31
    v_add_f32 v91, v91, v35
    v_cvt_pk_bf16_f32 v28, v84, v85
    v_cvt_pk_bf16_f32 v29, v86, v87
    v_cvt_pk_bf16_f32 v30, v88, v89
    v_cvt_pk_bf16_f32 v31, v90, v91
    s_cmp_eq_u32 s73, 1
    s_cbranch_scc1 L_f_v
    s_lshl_b32 s26, s25, 4
    v_add_u32 v33, s26, v2
    v_lshrrev_b32 v34, 1, v3
    v_lshl_add_u32 v34, v34, 5, v33
    v_lshlrev_b32 v34, 4, v34
    v_and_b32 v35, 1, v3
    v_lshl_add_u32 v34, v35, 3, v34
    v_add_u32 v34, s24, v34
    ds_write_b64 v34, v[28:29]
    v_cmp_eq_u32 vcc, 1, v3
    v_lshl_add_u32 v34, v3, 5, v33
    v_lshlrev_b32 v34, 3, v34
    v_cndmask_b32 v30, v30, v36, vcc
    v_cndmask_b32 v31, v31, v37, vcc
    v_add_u32 v34, s24, v34
    s_mov_b64 exec, 0xffffffff
    ds_write_b64 v34, v[30:31] offset:1024
    s_mov_b64 exec, -1
    v_mul_f32 v32, v84, v84
    v_fmac_f32 v32, v85, v85
    v_fmac_f32 v32, v86, v86
    v_fmac_f32 v32, v87, v87
    v_mul_f32 v39, v88, v88
    v_fmac_f32 v39, v89, v89
    v_fmac_f32 v39, v90, v90
    v_fmac_f32 v39, v91, v91
    v_cmp_eq_u32 vcc, 0, v3
    s_nop 1
    v_cndmask_b32 v39, 0, v39, vcc
    v_add_f32 v32, v32, v39
    v_mov_b32 v40, v32
    s_nop 1
    v_permlane32_swap_b32 v32, v40
    v_add_f32 v32, v32, v40
    v_mov_b32 v40, v32
    s_nop 1
    v_permlane16_swap_b32 v32, v40
    v_add_f32 v32, v32, v40
    s_nop 1
    v_max_f32_dpp v32, v32, v32 row_shr:1 row_mask:0xf bank_mask:0xf
    s_nop 1
    v_max_f32_dpp v32, v32, v32 row_shr:2 row_mask:0xf bank_mask:0xf
    s_nop 1
    v_max_f32_dpp v32, v32, v32 row_shr:4 row_mask:0xf bank_mask:0xf
    s_nop 1
    v_max_f32_dpp v32, v32, v32 row_shr:8 row_mask:0xf bank_mask:0xf
    s_lshl_b32 s27, s25, 2
    s_add_u32 s27, s27, s24
    v_mov_b32 v34, s27
    v_cmp_eq_u32 vcc, 15, v1
    s_and_saveexec_b64 s[30:31], vcc
    ds_write_b32 v34, v32 offset:1536
    s_mov_b64 exec, s[30:31]
    s_branch L_f_kvb
L_f_v:
    v_and_b32 v34, 1, v3
    v_lshl_add_u32 v34, v34, 5, v2
    v_lshlrev_b32 v34, 4, v34
    v_lshrrev_b32 v35, 1, v3
    v_lshl_add_u32 v34, v35, 3, v34
    s_lshl_b32 s26, s25, 10
    s_add_u32 s26, s26, s24
    v_add_u32 v34, s26, v34
    ds_write_b64 v34, v[28:29]
    v_cmp_eq_u32 vcc, 4, v2
    s_nop 1
    v_cndmask_b32 v30, v30, v36, vcc
    v_cndmask_b32 v31, v31, v36, vcc
    v_cmp_lt_u32 vcc, 4, v2
    s_nop 1
    v_cndmask_b32_e64 v30, v30, 0, vcc
    v_cndmask_b32_e64 v31, v31, 0, vcc
    ds_write_b64 v34, v[30:31] offset:256
L_f_kvb:
    s_waitcnt lgkmcnt(0)
    s_barrier
    s_cmp_eq_u32 s76, 1
    s_cbranch_scc0 L_f_kvd
    s_cmp_ge_u32 s75, 2
    s_cbranch_scc1 L_f_kvd
    s_lshl_b32 s24, s75, 11
    s_add_u32 s24, s24, 151552
    v_lshl_add_u32 v34, v1, 4, s24
    ds_read_b128 v[28:31], v34
    ds_read_b128 v[36:39], v34 offset:1024
    s_lshr_b32 s25, s77, 5
    s_add_u32 s25, s25, s75
    s_mul_i32 s24, s25, 3584
    s_add_u32 s24, s24, 1048576
    s_mul_i32 s26, s73, 1536
    s_add_u32 s24, s24, s26
    v_lshlrev_b32 v34, 4, v1
    s_waitcnt lgkmcnt(0)
    buffer_store_dwordx4 v[28:31], v34, s[8:11], s24 offen sc1
    s_cmp_eq_u32 s73, 1
    s_cbranch_scc1 L_f_kvs
    s_lshl_b32 s27, s25, 3
    s_add_u32 s27, s27, 98304
    v_mov_b32 v35, 0
    s_mov_b32 exec_lo, 0
    s_mov_b32 exec_hi, 1
    buffer_store_dwordx2 v[36:37], v35, s[8:11], s27 offen sc1
    s_mov_b32 exec_lo, -1
    s_mov_b32 exec_hi, 0
L_f_kvs:
    buffer_store_dwordx4 v[36:39], v34, s[8:11], s24 offen offset:1024 sc1
    s_mov_b64 exec, -1
    s_lshl_b32 s27, s25, 8
    s_lshl_b32 s28, s73, 7
    s_add_u32 s27, s27, s28
    s_add_u32 s37, s27, 31817728
    s_mov_b32 s38, 1
L_f_kvd:
    ds_read_b64_tr_b16 v[8:9], v96 offset:0
    ds_read_b64_tr_b16 v[10:11], v96 offset:2560
    ds_read_b64_tr_b16 v[12:13], v96 offset:8
    ds_read_b64_tr_b16 v[14:15], v96 offset:2568
    ds_read_b64_tr_b16 v[16:17], v96 offset:80
    ds_read_b64_tr_b16 v[18:19], v96 offset:2640
    ds_read_b64_tr_b16 v[20:21], v96 offset:88
    ds_read_b64_tr_b16 v[22:23], v96 offset:2648
    ds_read_b64_tr_b16 v[24:25], v97 offset:0
    ds_read_b64_tr_b16 v[26:27], v97 offset:2560
    ds_read_b64_tr_b16 v[36:37], v96 offset:5120
    ds_read_b64_tr_b16 v[38:39], v96 offset:7680
    ds_read_b64_tr_b16 v[40:41], v96 offset:5128
    ds_read_b64_tr_b16 v[42:43], v96 offset:7688
    ds_read_b64_tr_b16 v[44:45], v96 offset:5200
    ds_read_b64_tr_b16 v[46:47], v96 offset:7760
    ds_read_b64_tr_b16 v[48:49], v96 offset:5208
    ds_read_b64_tr_b16 v[50:51], v96 offset:7768
    ds_read_b64_tr_b16 v[52:53], v97 offset:5120
    ds_read_b64_tr_b16 v[54:55], v97 offset:7680
    s_waitcnt lgkmcnt(10)
    v_mfma_f32_16x16x32_bf16 v[64:67], v[8:11], v[100:103], v[64:67]
    v_mfma_f32_16x16x32_bf16 v[68:71], v[12:15], v[100:103], v[68:71]
    v_mfma_f32_16x16x32_bf16 v[72:75], v[16:19], v[100:103], v[72:75]
    v_mfma_f32_16x16x32_bf16 v[76:79], v[20:23], v[100:103], v[76:79]
    v_mfma_f32_16x16x32_bf16 v[80:83], v[24:27], v[100:103], v[80:83]
    ds_read_b64_tr_b16 v[8:9], v96 offset:10240
    ds_read_b64_tr_b16 v[10:11], v96 offset:12800
    ds_read_b64_tr_b16 v[12:13], v96 offset:10248
    ds_read_b64_tr_b16 v[14:15], v96 offset:12808
    ds_read_b64_tr_b16 v[16:17], v96 offset:10320
    ds_read_b64_tr_b16 v[18:19], v96 offset:12880
    ds_read_b64_tr_b16 v[20:21], v96 offset:10328
    ds_read_b64_tr_b16 v[22:23], v96 offset:12888
    ds_read_b64_tr_b16 v[24:25], v97 offset:10240
    ds_read_b64_tr_b16 v[26:27], v97 offset:12800
    s_waitcnt lgkmcnt(10)
    v_mfma_f32_16x16x32_bf16 v[64:67], v[36:39], v[104:107], v[64:67]
    v_mfma_f32_16x16x32_bf16 v[68:71], v[40:43], v[104:107], v[68:71]
    v_mfma_f32_16x16x32_bf16 v[72:75], v[44:47], v[104:107], v[72:75]
    v_mfma_f32_16x16x32_bf16 v[76:79], v[48:51], v[104:107], v[76:79]
    v_mfma_f32_16x16x32_bf16 v[80:83], v[52:55], v[104:107], v[80:83]
    ds_read_b64_tr_b16 v[36:37], v96 offset:15360
    ds_read_b64_tr_b16 v[38:39], v96 offset:17920
    ds_read_b64_tr_b16 v[40:41], v96 offset:15368
    ds_read_b64_tr_b16 v[42:43], v96 offset:17928
    ds_read_b64_tr_b16 v[44:45], v96 offset:15440
    ds_read_b64_tr_b16 v[46:47], v96 offset:18000
    ds_read_b64_tr_b16 v[48:49], v96 offset:15448
    ds_read_b64_tr_b16 v[50:51], v96 offset:18008
    ds_read_b64_tr_b16 v[52:53], v97 offset:15360
    ds_read_b64_tr_b16 v[54:55], v97 offset:17920
    s_waitcnt lgkmcnt(10)
    v_mfma_f32_16x16x32_bf16 v[64:67], v[8:11], v[108:111], v[64:67]
    v_mfma_f32_16x16x32_bf16 v[68:71], v[12:15], v[108:111], v[68:71]
    v_mfma_f32_16x16x32_bf16 v[72:75], v[16:19], v[108:111], v[72:75]
    v_mfma_f32_16x16x32_bf16 v[76:79], v[20:23], v[108:111], v[76:79]
    v_mfma_f32_16x16x32_bf16 v[80:83], v[24:27], v[108:111], v[80:83]
    s_cmp_eq_u32 s38, 1
    s_cbranch_scc0 L_f_nofl
    v_mov_b32 v98, 0
    v_mov_b32 v99, s79
    s_waitcnt vmcnt(0)
    s_mov_b64 exec, 1
    buffer_store_dword v99, v98, s[8:11], s37 offen sc1
    s_mov_b64 exec, -1
L_f_nofl:
    ds_read_b64_tr_b16 v[8:9], v96 offset:20480
    ds_read_b64_tr_b16 v[10:11], v96 offset:23040
    ds_read_b64_tr_b16 v[12:13], v96 offset:20488
    ds_read_b64_tr_b16 v[14:15], v96 offset:23048
    ds_read_b64_tr_b16 v[16:17], v96 offset:20560
    ds_read_b64_tr_b16 v[18:19], v96 offset:23120
    ds_read_b64_tr_b16 v[20:21], v96 offset:20568
    ds_read_b64_tr_b16 v[22:23], v96 offset:23128
    ds_read_b64_tr_b16 v[24:25], v97 offset:20480
    ds_read_b64_tr_b16 v[26:27], v97 offset:23040
    s_waitcnt lgkmcnt(10)
    v_mfma_f32_16x16x32_bf16 v[64:67], v[36:39], v[112:115], v[64:67]
    v_mfma_f32_16x16x32_bf16 v[68:71], v[40:43], v[112:115], v[68:71]
    v_mfma_f32_16x16x32_bf16 v[72:75], v[44:47], v[112:115], v[72:75]
    v_mfma_f32_16x16x32_bf16 v[76:79], v[48:51], v[112:115], v[76:79]
    v_mfma_f32_16x16x32_bf16 v[80:83], v[52:55], v[112:115], v[80:83]
    s_waitcnt vmcnt(0)
    s_barrier
    ds_read_b64_tr_b16 v[36:37], v92 offset:0
    ds_read_b64_tr_b16 v[38:39], v92 offset:2560
    ds_read_b64_tr_b16 v[40:41], v92 offset:8
    ds_read_b64_tr_b16 v[42:43], v92 offset:2568
    ds_read_b64_tr_b16 v[44:45], v92 offset:80
    ds_read_b64_tr_b16 v[46:47], v92 offset:2640
    ds_read_b64_tr_b16 v[48:49], v92 offset:88
    ds_read_b64_tr_b16 v[50:51], v92 offset:2648
    ds_read_b64_tr_b16 v[52:53], v93 offset:0
    ds_read_b64_tr_b16 v[54:55], v93 offset:2560
    s_waitcnt lgkmcnt(10)
    v_mfma_f32_16x16x32_bf16 v[64:67], v[8:11], v[116:119], v[64:67]
    v_mfma_f32_16x16x32_bf16 v[68:71], v[12:15], v[116:119], v[68:71]
    v_mfma_f32_16x16x32_bf16 v[72:75], v[16:19], v[116:119], v[72:75]
    v_mfma_f32_16x16x32_bf16 v[76:79], v[20:23], v[116:119], v[76:79]
    v_mfma_f32_16x16x32_bf16 v[80:83], v[24:27], v[116:119], v[80:83]
    ds_read_b64_tr_b16 v[8:9], v92 offset:5120
    ds_read_b64_tr_b16 v[10:11], v92 offset:7680
    ds_read_b64_tr_b16 v[12:13], v92 offset:5128
    ds_read_b64_tr_b16 v[14:15], v92 offset:7688
    ds_read_b64_tr_b16 v[16:17], v92 offset:5200
    ds_read_b64_tr_b16 v[18:19], v92 offset:7760
    ds_read_b64_tr_b16 v[20:21], v92 offset:5208
    ds_read_b64_tr_b16 v[22:23], v92 offset:7768
    ds_read_b64_tr_b16 v[24:25], v93 offset:5120
    ds_read_b64_tr_b16 v[26:27], v93 offset:7680
    s_waitcnt lgkmcnt(10)
    v_mfma_f32_16x16x32_bf16 v[64:67], v[36:39], v[120:123], v[64:67]
    v_mfma_f32_16x16x32_bf16 v[68:71], v[40:43], v[120:123], v[68:71]
    v_mfma_f32_16x16x32_bf16 v[72:75], v[44:47], v[120:123], v[72:75]
    v_mfma_f32_16x16x32_bf16 v[76:79], v[48:51], v[120:123], v[76:79]
    v_mfma_f32_16x16x32_bf16 v[80:83], v[52:55], v[120:123], v[80:83]
    ds_read_b64_tr_b16 v[36:37], v92 offset:10240
    ds_read_b64_tr_b16 v[38:39], v92 offset:12800
    ds_read_b64_tr_b16 v[40:41], v92 offset:10248
    ds_read_b64_tr_b16 v[42:43], v92 offset:12808
    ds_read_b64_tr_b16 v[44:45], v92 offset:10320
    ds_read_b64_tr_b16 v[46:47], v92 offset:12880
    ds_read_b64_tr_b16 v[48:49], v92 offset:10328
    ds_read_b64_tr_b16 v[50:51], v92 offset:12888
    ds_read_b64_tr_b16 v[52:53], v93 offset:10240
    ds_read_b64_tr_b16 v[54:55], v93 offset:12800
    s_waitcnt lgkmcnt(10)
    v_mfma_f32_16x16x32_bf16 v[64:67], v[8:11], v[124:127], v[64:67]
    v_mfma_f32_16x16x32_bf16 v[68:71], v[12:15], v[124:127], v[68:71]
    v_mfma_f32_16x16x32_bf16 v[72:75], v[16:19], v[124:127], v[72:75]
    v_mfma_f32_16x16x32_bf16 v[76:79], v[20:23], v[124:127], v[76:79]
    v_mfma_f32_16x16x32_bf16 v[80:83], v[24:27], v[124:127], v[80:83]
    ds_read_b64_tr_b16 v[8:9], v92 offset:15360
    ds_read_b64_tr_b16 v[10:11], v92 offset:17920
    ds_read_b64_tr_b16 v[12:13], v92 offset:15368
    ds_read_b64_tr_b16 v[14:15], v92 offset:17928
    ds_read_b64_tr_b16 v[16:17], v92 offset:15440
    ds_read_b64_tr_b16 v[18:19], v92 offset:18000
    ds_read_b64_tr_b16 v[20:21], v92 offset:15448
    ds_read_b64_tr_b16 v[22:23], v92 offset:18008
    ds_read_b64_tr_b16 v[24:25], v93 offset:15360
    ds_read_b64_tr_b16 v[26:27], v93 offset:17920
    s_waitcnt lgkmcnt(10)
    v_mfma_f32_16x16x32_bf16 v[64:67], v[36:39], v[128:131], v[64:67]
    v_mfma_f32_16x16x32_bf16 v[68:71], v[40:43], v[128:131], v[68:71]
    v_mfma_f32_16x16x32_bf16 v[72:75], v[44:47], v[128:131], v[72:75]
    v_mfma_f32_16x16x32_bf16 v[76:79], v[48:51], v[128:131], v[76:79]
    v_mfma_f32_16x16x32_bf16 v[80:83], v[52:55], v[128:131], v[80:83]
    ds_read_b64_tr_b16 v[36:37], v92 offset:20480
    ds_read_b64_tr_b16 v[38:39], v92 offset:23040
    ds_read_b64_tr_b16 v[40:41], v92 offset:20488
    ds_read_b64_tr_b16 v[42:43], v92 offset:23048
    ds_read_b64_tr_b16 v[44:45], v92 offset:20560
    ds_read_b64_tr_b16 v[46:47], v92 offset:23120
    ds_read_b64_tr_b16 v[48:49], v92 offset:20568
    ds_read_b64_tr_b16 v[50:51], v92 offset:23128
    ds_read_b64_tr_b16 v[52:53], v93 offset:20480
    ds_read_b64_tr_b16 v[54:55], v93 offset:23040
    s_waitcnt lgkmcnt(10)
    v_mfma_f32_16x16x32_bf16 v[64:67], v[8:11], v[132:135], v[64:67]
    v_mfma_f32_16x16x32_bf16 v[68:71], v[12:15], v[132:135], v[68:71]
    v_mfma_f32_16x16x32_bf16 v[72:75], v[16:19], v[132:135], v[72:75]
    v_mfma_f32_16x16x32_bf16 v[76:79], v[20:23], v[132:135], v[76:79]
    v_mfma_f32_16x16x32_bf16 v[80:83], v[24:27], v[132:135], v[80:83]
    s_waitcnt lgkmcnt(0)
    v_mfma_f32_16x16x32_bf16 v[64:67], v[36:39], v[136:139], v[64:67]
    v_mfma_f32_16x16x32_bf16 v[68:71], v[40:43], v[136:139], v[68:71]
    v_mfma_f32_16x16x32_bf16 v[72:75], v[44:47], v[136:139], v[72:75]
    v_mfma_f32_16x16x32_bf16 v[76:79], v[48:51], v[136:139], v[76:79]
    v_mfma_f32_16x16x32_bf16 v[80:83], v[52:55], v[136:139], v[80:83]
    s_barrier
    s_mul_i32 s27, s74, 5120
    v_lshl_add_u32 v6, v1, 4, s27
    s_xor_b32 s28, s74, 4
    s_mul_i32 s28, s28, 5120
    v_lshl_add_u32 v7, v1, 4, s28
    s_nop 4
    ds_write_b128 v6, v[64:67] offset:0
    ds_write_b128 v6, v[68:71] offset:1024
    ds_write_b128 v6, v[72:75] offset:2048
    ds_write_b128 v6, v[76:79] offset:3072
    ds_write_b128 v6, v[80:83] offset:4096
    s_waitcnt lgkmcnt(0)
    s_barrier
    ds_read_b128 v[100:103], v7 offset:0
    ds_read_b128 v[104:107], v7 offset:1024
    ds_read_b128 v[108:111], v7 offset:2048
    ds_read_b128 v[112:115], v7 offset:3072
    ds_read_b128 v[116:119], v7 offset:4096
    s_waitcnt lgkmcnt(0)
    v_pk_add_f32 v[64:65], v[64:65], v[100:101]
    v_pk_add_f32 v[66:67], v[66:67], v[102:103]
    v_pk_add_f32 v[68:69], v[68:69], v[104:105]
    v_pk_add_f32 v[70:71], v[70:71], v[106:107]
    v_pk_add_f32 v[72:73], v[72:73], v[108:109]
    v_pk_add_f32 v[74:75], v[74:75], v[110:111]
    v_pk_add_f32 v[76:77], v[76:77], v[112:113]
    v_pk_add_f32 v[78:79], v[78:79], v[114:115]
    v_pk_add_f32 v[80:81], v[80:81], v[116:117]
    v_pk_add_f32 v[82:83], v[82:83], v[118:119]
    v_mul_f32 v64, 0x3ea52b5c, v64
    v_mul_f32 v65, 0x3ea52b5c, v65
    v_mul_f32 v66, 0x3ea52b5c, v66
    v_mul_f32 v67, 0x3ea52b5c, v67
    v_mul_f32 v68, 0x3ea52b5c, v68
    v_mul_f32 v69, 0x3ea52b5c, v69
    v_mul_f32 v70, 0x3ea52b5c, v70
    v_mul_f32 v71, 0x3ea52b5c, v71
    v_mul_f32 v72, 0x3ea52b5c, v72
    v_mul_f32 v73, 0x3ea52b5c, v73
    v_mul_f32 v74, 0x3ea52b5c, v74
    v_mul_f32 v75, 0x3ea52b5c, v75
    v_mul_f32 v76, 0x3ea52b5c, v76
    v_mul_f32 v77, 0x3ea52b5c, v77
    v_mul_f32 v78, 0x3ea52b5c, v78
    v_mul_f32 v79, 0x3ea52b5c, v79
    v_mul_f32 v80, 0x3ea52b5c, v80
    v_mul_f32 v81, 0x3ea52b5c, v81
    v_mul_f32 v82, 0x3ea52b5c, v82
    v_mul_f32 v83, 0x3ea52b5c, v83
    v_cvt_pk_bf16_f32 v8, v64, v65
    v_cvt_pk_bf16_f32 v9, v66, v67
    v_cvt_pk_bf16_f32 v10, v68, v69
    v_cvt_pk_bf16_f32 v11, v70, v71
    v_cvt_pk_bf16_f32 v12, v72, v73
    v_cvt_pk_bf16_f32 v13, v74, v75
    v_cvt_pk_bf16_f32 v14, v76, v77
    v_cvt_pk_bf16_f32 v15, v78, v79
    v_cvt_pk_bf16_f32 v16, v80, v81
    v_cvt_pk_bf16_f32 v17, v82, v83
    v_mov_b32 v18, v16
    v_mov_b32 v19, v17
    s_nop 1
    v_permlane32_swap_b32 v16, v18
    v_permlane32_swap_b32 v17, v19
    s_mov_b32 exec_lo, 0
    v_mov_b32 v16, 0
    v_mov_b32 v17, 0
    v_mov_b32 v18, 0
    v_mov_b32 v19, 0
    s_mov_b32 exec_lo, -1
    v_lshlrev_b32 v6, 4, v1
    v_lshlrev_b32 v7, 3, v1
    s_mul_i32 s24, s76, 7168
    s_add_u32 s24, s24, 102400
    v_add_u32 v4, s24, v6
    s_add_u32 s24, s24, 1024
    v_add_u32 v5, s24, v7
    s_sub_u32 s84, s74, 5
    s_lshl_b32 s84, s84, 10
    s_add_u32 s85, s84, 12288
    s_min_u32 s85, s85, 13312
    s_lshl_b32 s24, s74, 8
    s_lshl_b32 s25, s70, 5
    s_add_u32 s24, s24, s25
    s_add_u32 s24, s24, s71
    s_mov_b32 s96, s24
    s_cmp_ge_u32 s24, 1232
    s_cbranch_scc1 L_pd_none
    s_mov_b32 s33, 4
    s_mov_b32 s97, 0
    s_mov_b32 s87, 5
    s_mov_b32 s35, 1280
    s_cmp_lt_u32 s24, 160
    s_cbranch_scc1 L_pp_wo
    s_cmp_lt_u32 s24, 320
    s_cbranch_scc1 L_pp_w1
    s_cmp_lt_u32 s24, 480
    s_cbranch_scc1 L_pp_w2
    s_cmp_lt_u32 s24, 800
    s_cbranch_scc1 L_pp_w3
    s_sub_u32 s24, s24, 800
    s_mul_hi_u32 s25, s24, 79536432
    s_mul_i32 s26, s25, 54
    s_sub_u32 s26, s24, s26
    s_mov_b32 s12, s58
    s_mov_b32 s13, s59
    s_mov_b32 s14, 2211840
    s_mov_b32 s15, 0x00020000
    s_mul_i32 s36, s25, 160
    s_mul_i32 s86, s24, 5120
    s_add_u32 s86, s86, 7864320
    s_cmp_ge_u32 s26, 48
    s_cbranch_scc1 L_pp_w4b
    s_mul_hi_u32 s27, s26, 1431655766
    s_mul_i32 s28, s27, 3
    s_sub_u32 s28, s26, s28
    s_mul_i32 s32, s27, 112
    s_sub_u32 s29, s27, 12
    s_mul_i32 s29, s29, 96
    s_add_u32 s29, s29, 1344
    s_cmp_lt_u32 s27, 12
    s_cselect_b32 s32, s32, s29
    s_lshl_b32 s29, s28, 5
    s_add_u32 s32, s32, s29
    s_mov_b32 s34, 16
    s_branch L_pp_go
L_pp_w4b:
    s_sub_u32 s29, s26, 48
    s_mul_i32 s32, s29, 224
    s_add_u32 s32, s32, 96
    s_mov_b32 s34, 112
    s_branch L_pp_go
L_pp_wo:
    s_mul_hi_u32 s25, s24, 214748365
    s_mul_i32 s26, s25, 20
    s_sub_u32 s26, s24, s26
    s_mov_b32 s12, s48
    s_mov_b32 s13, s49
    s_mov_b32 s14, 819200
    s_mov_b32 s15, 0x00020000
    s_mul_i32 s36, s25, 160
    s_mul_i32 s86, s24, 5120
    s_add_u32 s86, s86, 2359296
    s_lshl_b32 s32, s26, 2
    s_mov_b32 s97, 2
    s_branch L_pp_go
L_pp_w1:
    s_sub_u32 s24, s24, 160
    s_mul_hi_u32 s25, s24, 214748365
    s_mul_i32 s26, s25, 20
    s_sub_u32 s26, s24, s26
    s_mov_b32 s12, s52
    s_mov_b32 s13, s53
    s_mov_b32 s14, 819200
    s_mov_b32 s15, 0x00020000
    s_mul_i32 s36, s25, 160
    s_mul_i32 s86, s24, 5120
    s_add_u32 s86, s86, 3407872
    s_mov_b32 s97, 1
    s_mul_hi_u32 s27, s26, 858993460
    s_mul_i32 s28, s27, 5
    s_sub_u32 s28, s26, s28
    s_cmp_eq_u32 s28, 4
    s_cbranch_scc1 L_pi_16
    s_mul_i32 s32, s27, 160
    s_lshr_b32 s29, s28, 1
    s_mul_i32 s29, s29, 80
    s_add_u32 s32, s32, s29
    s_and_b32 s29, s28, 1
    s_lshl_b32 s29, s29, 5
    s_add_u32 s32, s32, s29
    s_mov_b32 s34, 16
    s_branch L_pi_17
L_pi_16:
    s_mul_i32 s32, s27, 160
    s_add_u32 s32, s32, 64
    s_mov_b32 s34, 80
L_pi_17:
    s_branch L_pp_go
L_pp_w2:
    s_sub_u32 s24, s24, 320
    s_mul_hi_u32 s25, s24, 214748365
    s_mul_i32 s26, s25, 20
    s_sub_u32 s26, s24, s26
    s_mov_b32 s12, s54
    s_mov_b32 s13, s55
    s_mov_b32 s14, 819200
    s_mov_b32 s15, 0x00020000
    s_mul_i32 s36, s25, 160
    s_mul_i32 s86, s24, 5120
    s_add_u32 s86, s86, 4456448
    s_mov_b32 s97, 0
    s_mul_hi_u32 s27, s26, 858993460
    s_mul_i32 s28, s27, 5
    s_sub_u32 s28, s26, s28
    s_cmp_eq_u32 s28, 4
    s_cbranch_scc1 L_pi_18
    s_mul_i32 s32, s27, 160
    s_lshr_b32 s29, s28, 1
    s_mul_i32 s29, s29, 80
    s_add_u32 s32, s32, s29
    s_and_b32 s29, s28, 1
    s_lshl_b32 s29, s29, 5
    s_add_u32 s32, s32, s29
    s_mov_b32 s34, 16
    s_branch L_pi_19
L_pi_18:
    s_mul_i32 s32, s27, 160
    s_add_u32 s32, s32, 64
    s_mov_b32 s34, 80
L_pi_19:
    s_branch L_pp_go
L_pp_w3:
    s_sub_u32 s24, s24, 480
    s_mul_hi_u32 s25, s24, 214748365
    s_mul_i32 s26, s25, 20
    s_sub_u32 s26, s24, s26
    s_mov_b32 s12, s56
    s_mov_b32 s13, s57
    s_mov_b32 s14, 2211840
    s_mov_b32 s15, 0x00020000
    s_mul_i32 s36, s25, 224
    s_sub_u32 s29, s25, 12
    s_mul_i32 s29, s29, 192
    s_add_u32 s29, s29, 2688
    s_cmp_lt_u32 s25, 12
    s_cselect_b32 s36, s36, s29
    s_mul_i32 s86, s24, 7168
    s_add_u32 s86, s86, 5505024
    s_mov_b32 s35, 3456
    s_mov_b32 s87, 7
    s_mov_b32 s97, 3
    s_mul_hi_u32 s27, s26, 858993460
    s_mul_i32 s28, s27, 5
    s_sub_u32 s28, s26, s28
    s_cmp_eq_u32 s28, 4
    s_cbranch_scc1 L_pi_20
    s_mul_i32 s32, s27, 160
    s_lshr_b32 s29, s28, 1
    s_mul_i32 s29, s29, 80
    s_add_u32 s32, s32, s29
    s_and_b32 s29, s28, 1
    s_lshl_b32 s29, s29, 5
    s_add_u32 s32, s32, s29
    s_mov_b32 s34, 16
    s_branch L_pi_21
L_pi_20:
    s_mul_i32 s32, s27, 160
    s_add_u32 s32, s32, 64
    s_mov_b32 s34, 80
L_pi_21:
L_pp_go:
    s_mov_b32 s88, s36
    s_mov_b32 s89, s32
    s_mov_b32 s90, s34
    s_mul_i32 s29, s74, 7168
    s_lshl_b32 s30, s87, 1
    s_movk_i32 s31, 4682
    s_cmp_eq_u32 s87, 5
    s_cselect_b32 s31, 6554, s31
    v_mul_u32_u24 v160, s31, v1
    v_lshrrev_b32 v160, 16, v160
    v_mul_u32_u24 v161, s30, v160
    v_sub_u32 v161, v1, v161
    v_mul_lo_u32 v160, v160, s35
    v_lshl_add_u32 v160, v161, 4, v160
    s_lshl_b32 s31, s30, 6
L_pd_none:
    s_cmp_lg_u32 s74, 7
    s_cbranch_scc1 L_kvw
    s_mov_b32 s28, 31817728
    v_lshlrev_b32 v22, 8, v1
    s_mov_b32 s101, 0x40000
L_kvp_22:
    buffer_load_dword v20, v22, s[8:11], s28 offen sc1
    buffer_load_dword v21, v22, s[8:11], s28 offen offset:128 sc1
    s_waitcnt vmcnt(0)
    v_cmp_ne_u32 vcc, s79, v20
    v_cmp_ne_u32 s[26:27], s79, v21
    s_or_b64 vcc, vcc, s[26:27]
    s_sub_u32 s101, s101, 1
    s_cmp_eq_u64 vcc, 0
    s_cbranch_scc1 L_kvpd_23
    s_sleep 4
    s_cmp_lg_u32 s101, 0
    s_cbranch_scc1 L_kvp_22
L_kvpd_23:
L_kvw:
    s_barrier
    v_lshlrev_b32 v20, 3, v1
    s_mov_b32 s27, 98304
    buffer_load_dwordx2 v[22:23], v20, s[8:11], s27 offen sc1
    v_mov_b32 v25, 0
    v_mov_b32 v26, 0
    v_mov_b32 v27, 0
    s_cmp_lt_u32 s74, 5
    s_cbranch_scc1 L_kv0
    s_add_u32 s82, s84, 1048576
    s_add_u32 m0, s84, 102400
    s_add_u32 s83, s82, 0
    buffer_load_dwordx4 v6, s[8:11], s83 offen lds
    s_add_u32 m0, s84, 105472
    s_add_u32 s83, s82, 3072
    buffer_load_dwordx4 v6, s[8:11], s83 offen lds
    s_add_u32 m0, s84, 108544
    s_add_u32 s83, s82, 6144
    buffer_load_dwordx4 v6, s[8:11], s83 offen lds
    s_add_u32 m0, s84, 111616
    s_add_u32 s83, s82, 9216
    buffer_load_dwordx4 v6, s[8:11], s83 offen lds
    s_add_u32 m0, s85, 102400
    s_sub_u32 s83, s82, s84
    s_add_u32 s83, s83, s85
    buffer_load_dwordx4 v6, s[8:11], s83 offen lds
    s_add_u32 s82, s82, 14336
    s_add_u32 m0, s84, 116736
    s_add_u32 s83, s82, 0
    buffer_load_dwordx4 v6, s[8:11], s83 offen lds
    s_add_u32 m0, s84, 119808
    s_add_u32 s83, s82, 3072
    buffer_load_dwordx4 v6, s[8:11], s83 offen lds
    s_add_u32 m0, s84, 122880
    s_add_u32 s83, s82, 6144
    buffer_load_dwordx4 v6, s[8:11], s83 offen lds
    s_add_u32 m0, s84, 125952
    s_add_u32 s83, s82, 9216
    buffer_load_dwordx4 v6, s[8:11], s83 offen lds
    s_add_u32 m0, s85, 116736
    s_sub_u32 s83, s82, s84
    s_add_u32 s83, s83, s85
    buffer_load_dwordx4 v6, s[8:11], s83 offen lds
    s_add_u32 s82, s82, 14336
    s_add_u32 m0, s84, 131072
    s_add_u32 s83, s82, 0
    buffer_load_dwordx4 v6, s[8:11], s83 offen lds
    s_add_u32 m0, s84, 134144
    s_add_u32 s83, s82, 3072
    buffer_load_dwordx4 v6, s[8:11], s83 offen lds
    s_add_u32 m0, s84, 137216
    s_add_u32 s83, s82, 6144
    buffer_load_dwordx4 v6, s[8:11], s83 offen lds
    s_add_u32 m0, s84, 140288
    s_add_u32 s83, s82, 9216
    buffer_load_dwordx4 v6, s[8:11], s83 offen lds
    s_add_u32 m0, s85, 131072
    s_sub_u32 s83, s82, s84
    s_add_u32 s83, s83, s85
    buffer_load_dwordx4 v6, s[8:11], s83 offen lds
    s_add_u32 s82, s82, 14336
L_kv0:
    v_dot2c_f32_bf16 v25, v8, v8
    v_dot2c_f32_bf16 v26, v12, v12
    v_dot2c_f32_bf16 v25, v9, v9
    v_dot2c_f32_bf16 v26, v13, v13
    v_dot2c_f32_bf16 v25, v10, v10
    v_dot2c_f32_bf16 v26, v14, v14
    v_dot2c_f32_bf16 v25, v11, v11
    v_dot2c_f32_bf16 v26, v15, v15
    v_dot2c_f32_bf16 v27, v16, v16
    v_dot2c_f32_bf16 v27, v17, v17
    v_dot2c_f32_bf16 v27, v18, v18
    v_dot2c_f32_bf16 v27, v19, v19
    s_cmp_lt_u32 s74, 5
    s_cbranch_scc1 L_sw_24
    s_waitcnt vmcnt(10)
    s_branch L_sw_25
L_sw_24:
    s_waitcnt vmcnt(0)
L_sw_25:
    v_max_f32 v21, v22, v23
    v_max3_f32 v25, v25, v26, v27
    s_nop 0
    v_max_f32_dpp v21, v21, v21 row_shr:1 row_mask:0xf bank_mask:0xf
    v_max_f32_dpp v25, v25, v25 row_shr:1 row_mask:0xf bank_mask:0xf
    s_nop 0
    v_max_f32_dpp v21, v21, v21 row_shr:2 row_mask:0xf bank_mask:0xf
    v_max_f32_dpp v25, v25, v25 row_shr:2 row_mask:0xf bank_mask:0xf
    s_nop 0
    v_max_f32_dpp v21, v21, v21 row_shr:4 row_mask:0xf bank_mask:0xf
    v_max_f32_dpp v25, v25, v25 row_shr:4 row_mask:0xf bank_mask:0xf
    s_nop 0
    v_max_f32_dpp v21, v21, v21 row_shr:8 row_mask:0xf bank_mask:0xf
    v_max_f32_dpp v25, v25, v25 row_shr:8 row_mask:0xf bank_mask:0xf
    s_nop 0
    v_max_f32_dpp v21, v21, v21 row_bcast:15 row_mask:0xa bank_mask:0xf
    v_max_f32_dpp v25, v25, v25 row_bcast:15 row_mask:0xa bank_mask:0xf
    s_nop 0
    v_max_f32_dpp v21, v21, v21 row_bcast:31 row_mask:0xc bank_mask:0xf
    v_max_f32_dpp v25, v25, v25 row_bcast:31 row_mask:0xc bank_mask:0xf
    s_nop 0
    v_mul_f32 v21, v21, v25
    v_mul_f32 v21, 0x40400000, v21
    s_nop 0
    v_readlane_b32 s28, v21, 63
    s_nop 1
    v_mov_b32 v22, s28
    v_mov_b32 v23, 0x45bb8000
    v_cmp_nle_f32 vcc, v22, v23
    s_cmp_lg_u64 vcc, 0
    s_cselect_b32 s28, 1, 0
    v_mov_b32 v22, s28
    s_lshl_b32 s29, s74, 2
    s_add_u32 s29, s29, 151552
    v_mov_b32 v23, s29
    ds_write_b32 v23, v22
    s_waitcnt lgkmcnt(0)
    s_barrier
    v_and_b32 v23, 7, v1
    v_lshlrev_b32 v23, 2, v23
    v_add_u32 v23, 151552, v23
    ds_read_b32 v22, v23 offset:0
    s_waitcnt lgkmcnt(0)
    v_cmp_ne_u32 vcc, 0, v22
    s_cmp_lg_u64 vcc, 0
    s_cbranch_scc0 L_at_fast
    v_mov_b32 v96, 0xff7fffff
    v_mov_b32 v97, 0xff7fffff
    s_add_u32 s82, s84, 1048576
    s_mov_b32 s80, 0
L_mx_loop:
    s_barrier
    s_cmp_lt_u32 s74, 5
    s_cbranch_scc1 L_mx_nd
    s_add_u32 m0, s84, 102400
    s_add_u32 s83, s82, 0
    buffer_load_dwordx4 v6, s[8:11], s83 offen lds
    s_add_u32 m0, s84, 105472
    s_add_u32 s83, s82, 3072
    buffer_load_dwordx4 v6, s[8:11], s83 offen lds
    s_add_u32 m0, s84, 108544
    s_add_u32 s83, s82, 6144
    buffer_load_dwordx4 v6, s[8:11], s83 offen lds
    s_add_u32 m0, s84, 111616
    s_add_u32 s83, s82, 9216
    buffer_load_dwordx4 v6, s[8:11], s83 offen lds
    s_add_u32 m0, s85, 102400
    s_sub_u32 s83, s82, s84
    s_add_u32 s83, s83, s85
    buffer_load_dwordx4 v6, s[8:11], s83 offen lds
    s_add_u32 s82, s82, 14336
L_mx_nd:
    s_waitcnt vmcnt(0)
    s_barrier
    ds_read_b128 v[20:23], v4 offset:0
    ds_read_b64 v[24:25], v5 offset:0
    s_waitcnt lgkmcnt(0)
    v_mfma_f32_32x32x16_bf16 v[48:63], v[20:23], v[8:11], 0
    v_mfma_f32_32x32x8bf16_1k v[48:63], v[24:25], v[16:17], v[48:63]
    v_mfma_f32_32x32x16_bf16 v[64:79], v[20:23], v[12:15], 0
    v_mfma_f32_32x32x8bf16_1k v[64:79], v[24:25], v[18:19], v[64:79]
    s_nop 15
    v_max3_f32 v96, v48, v49, v96
    v_max3_f32 v97, v64, v65, v97
    v_max3_f32 v96, v50, v51, v96
    v_max3_f32 v97, v66, v67, v97
    v_max3_f32 v96, v52, v53, v96
    v_max3_f32 v97, v68, v69, v97
    v_max3_f32 v96, v54, v55, v96
    v_max3_f32 v97, v70, v71, v97
    v_max3_f32 v96, v56, v57, v96
    v_max3_f32 v97, v72, v73, v97
    v_max3_f32 v96, v58, v59, v96
    v_max3_f32 v97, v74, v75, v97
    v_max3_f32 v96, v60, v61, v96
    v_max3_f32 v97, v76, v77, v97
    v_max3_f32 v96, v62, v63, v96
    v_max3_f32 v97, v78, v79, v97
    ds_read_b128 v[20:23], v4 offset:3584
    ds_read_b64 v[24:25], v5 offset:3584
    s_waitcnt lgkmcnt(0)
    v_mfma_f32_32x32x16_bf16 v[48:63], v[20:23], v[8:11], 0
    v_mfma_f32_32x32x8bf16_1k v[48:63], v[24:25], v[16:17], v[48:63]
    v_mfma_f32_32x32x16_bf16 v[64:79], v[20:23], v[12:15], 0
    v_mfma_f32_32x32x8bf16_1k v[64:79], v[24:25], v[18:19], v[64:79]
    s_nop 15
    v_max3_f32 v96, v48, v49, v96
    v_max3_f32 v97, v64, v65, v97
    v_max3_f32 v96, v50, v51, v96
    v_max3_f32 v97, v66, v67, v97
    v_max3_f32 v96, v52, v53, v96
    v_max3_f32 v97, v68, v69, v97
    v_max3_f32 v96, v54, v55, v96
    v_max3_f32 v97, v70, v71, v97
    v_max3_f32 v96, v56, v57, v96
    v_max3_f32 v97, v72, v73, v97
    v_max3_f32 v96, v58, v59, v96
    v_max3_f32 v97, v74, v75, v97
    v_max3_f32 v96, v60, v61, v96
    v_max3_f32 v97, v76, v77, v97
    v_max3_f32 v96, v62, v63, v96
    v_max3_f32 v97, v78, v79, v97
    s_add_u32 s80, s80, 1
    s_cmp_lt_u32 s80, 16
    s_cbranch_scc1 L_mx_loop
    v_mov_b32 v98, v96
    v_mov_b32 v99, v97
    s_nop 1
    v_permlane32_swap_b32 v96, v98
    v_permlane32_swap_b32 v97, v99
    v_max_f32 v96, v96, v98
    v_max_f32 v97, v97, v99
    s_barrier
    s_lshl_b32 s24, s74, 9
    s_add_u32 s24, s24, 102400
    v_lshl_add_u32 v98, v1, 3, s24
    s_xor_b32 s25, s74, 4
    s_lshl_b32 s25, s25, 9
    s_add_u32 s25, s25, 102400
    v_lshl_add_u32 v99, v1, 3, s25
    ds_write_b64 v98, v[96:97]
    s_waitcnt lgkmcnt(0)
    s_barrier
    ds_read_b64 v[100:101], v99
    s_waitcnt lgkmcnt(0)
    v_max_f32 v96, v96, v100
    v_max_f32 v97, v97, v101
    s_barrier
    v_sub_f32 v100, 0, v96
    v_and_b32 v101, 0xffff0000, v100
    v_sub_f32 v100, v100, v101
    v_and_b32 v102, 0xffff0000, v100
    v_sub_f32 v100, v100, v102
    v_lshrrev_b32 v101, 16, v101
    v_or_b32 v101, v101, v102
    v_lshrrev_b32 v100, 16, v100
    s_mov_b32 exec_lo, 0
    v_mov_b32 v16, v101
    v_mov_b32 v17, v100
    s_mov_b32 exec_lo, -1
    v_sub_f32 v100, 0, v97
    v_and_b32 v101, 0xffff0000, v100
    v_sub_f32 v100, v100, v101
    v_and_b32 v102, 0xffff0000, v100
    v_sub_f32 v100, v100, v102
    v_lshrrev_b32 v101, 16, v101
    v_or_b32 v101, v101, v102
    v_lshrrev_b32 v100, 16, v100
    s_mov_b32 exec_lo, 0
    v_mov_b32 v18, v101
    v_mov_b32 v19, v100
    s_mov_b32 exec_lo, -1
    s_cmp_lt_u32 s74, 5
    s_cbranch_scc1 L_kv1
    s_add_u32 s82, s84, 1048576
    s_add_u32 m0, s84, 102400
    s_add_u32 s83, s82, 0
    buffer_load_dwordx4 v6, s[8:11], s83 offen lds
    s_add_u32 m0, s84, 105472
    s_add_u32 s83, s82, 3072
    buffer_load_dwordx4 v6, s[8:11], s83 offen lds
    s_add_u32 m0, s84, 108544
    s_add_u32 s83, s82, 6144
    buffer_load_dwordx4 v6, s[8:11], s83 offen lds
    s_add_u32 m0, s84, 111616
    s_add_u32 s83, s82, 9216
    buffer_load_dwordx4 v6, s[8:11], s83 offen lds
    s_add_u32 m0, s85, 102400
    s_sub_u32 s83, s82, s84
    s_add_u32 s83, s83, s85
    buffer_load_dwordx4 v6, s[8:11], s83 offen lds
    s_add_u32 s82, s82, 14336
    s_add_u32 m0, s84, 116736
    s_add_u32 s83, s82, 0
    buffer_load_dwordx4 v6, s[8:11], s83 offen lds
    s_add_u32 m0, s84, 119808
    s_add_u32 s83, s82, 3072
    buffer_load_dwordx4 v6, s[8:11], s83 offen lds
    s_add_u32 m0, s84, 122880
    s_add_u32 s83, s82, 6144
    buffer_load_dwordx4 v6, s[8:11], s83 offen lds
    s_add_u32 m0, s84, 125952
    s_add_u32 s83, s82, 9216
    buffer_load_dwordx4 v6, s[8:11], s83 offen lds
    s_add_u32 m0, s85, 116736
    s_sub_u32 s83, s82, s84
    s_add_u32 s83, s83, s85
    buffer_load_dwordx4 v6, s[8:11], s83 offen lds
    s_add_u32 s82, s82, 14336
    s_add_u32 m0, s84, 131072
    s_add_u32 s83, s82, 0
    buffer_load_dwordx4 v6, s[8:11], s83 offen lds
    s_add_u32 m0, s84, 134144
    s_add_u32 s83, s82, 3072
    buffer_load_dwordx4 v6, s[8:11], s83 offen lds
    s_add_u32 m0, s84, 137216
    s_add_u32 s83, s82, 6144
    buffer_load_dwordx4 v6, s[8:11], s83 offen lds
    s_add_u32 m0, s84, 140288
    s_add_u32 s83, s82, 9216
    buffer_load_dwordx4 v6, s[8:11], s83 offen lds
    s_add_u32 m0, s85, 131072
    s_sub_u32 s83, s82, s84
    s_add_u32 s83, s83, s85
    buffer_load_dwordx4 v6, s[8:11], s83 offen lds
    s_add_u32 s82, s82, 14336
L_kv1:
    s_waitcnt vmcnt(0)
    s_barrier
L_at_fast:
    s_lshl_b32 s24, 41, s74
    s_or_b32 s81, s24, 32259
    s_or_b32 s25, s24, 7171
    s_cmp_eq_u32 s74, 4
    s_cselect_b32 s81, s25, s81
    s_cmp_gt_u32 s74, 4
    s_cselect_b32 s81, 3, s81
    s_barrier
    ds_read_b128 v[20:23], v4
    ds_read_b64 v[24:25], v5
    v_mov_b64 v[96:97], 0
    v_mov_b64 v[112:113], 0
    v_mov_b64 v[98:99], 0
    v_mov_b64 v[114:115], 0
    v_mov_b64 v[100:101], 0
    v_mov_b64 v[116:117], 0
    v_mov_b64 v[102:103], 0
    v_mov_b64 v[118:119], 0
    v_mov_b64 v[104:105], 0
    v_mov_b64 v[120:121], 0
    v_mov_b64 v[106:107], 0
    v_mov_b64 v[122:123], 0
    v_mov_b64 v[108:109], 0
    v_mov_b64 v[124:125], 0
    v_mov_b64 v[110:111], 0
    v_mov_b64 v[126:127], 0
    v_mov_b64 v[88:89], 0
    v_mov_b64 v[40:41], 0
    v_mov_b64 v[90:91], 0
    v_mov_b64 v[42:43], 0
    v_mov_b64 v[92:93], 0
    v_mov_b64 v[44:45], 0
    v_mov_b64 v[94:95], 0
    v_mov_b64 v[46:47], 0
    s_waitcnt lgkmcnt(0)
    v_mfma_f32_32x32x16_bf16 v[48:63], v[20:23], v[8:11], 0
    v_mfma_f32_32x32x8bf16_1k v[48:63], v[24:25], v[16:17], v[48:63]
    s_mov_b32 s80, 0
    s_nop 11
.p2align 6
L_at_loop:
    s_setprio 2
    ds_read_b128 v[32:35], v4 offset:1536
    ds_read_b128 v[36:39], v4 offset:2560
    ds_read_b128 v[28:31], v4 offset:3584
    ds_read_b64 v[26:27], v5 offset:3584
    v_exp_f32 v48, v48
    v_mfma_f32_32x32x16_bf16 v[64:79], v[20:23], v[12:15], 0
    v_exp_f32 v49, v49
    v_exp_f32 v50, v50
    v_exp_f32 v51, v51
    v_exp_f32 v52, v52
    v_mfma_f32_32x32x8bf16_1k v[64:79], v[24:25], v[18:19], v[64:79]
    v_cvt_pk_bf16_f32 v80, v48, v49
    v_exp_f32 v53, v53
    v_exp_f32 v54, v54
    v_cvt_pk_bf16_f32 v81, v50, v51
    v_exp_f32 v55, v55
    v_mfma_f32_32x32x16_bf16 v[112:127], v[40:43], v[88:91], v[112:127]
    v_exp_f32 v56, v56
    v_cvt_pk_bf16_f32 v82, v52, v53
    v_exp_f32 v57, v57
    v_exp_f32 v58, v58
    v_cvt_pk_bf16_f32 v83, v54, v55
    v_mfma_f32_32x32x16_bf16 v[112:127], v[44:47], v[92:95], v[112:127]
    v_exp_f32 v59, v59
    v_exp_f32 v60, v60
    v_cvt_pk_bf16_f32 v84, v56, v57
    v_exp_f32 v61, v61
    v_exp_f32 v62, v62
    v_cvt_pk_bf16_f32 v85, v58, v59
    v_exp_f32 v63, v63
    v_cvt_pk_bf16_f32 v86, v60, v61
    v_cvt_pk_bf16_f32 v87, v62, v63
    s_setprio 1
    v_exp_f32 v64, v64
    v_exp_f32 v65, v65
    s_waitcnt lgkmcnt(0)
    v_mfma_f32_32x32x16_bf16 v[96:111], v[32:35], v[80:83], v[96:111]
    v_exp_f32 v66, v66
    v_exp_f32 v67, v67
    v_exp_f32 v68, v68
    v_cvt_pk_bf16_f32 v88, v64, v65
    v_mfma_f32_32x32x16_bf16 v[96:111], v[36:39], v[84:87], v[96:111]
    v_exp_f32 v69, v69
    v_exp_f32 v70, v70
    v_cvt_pk_bf16_f32 v89, v66, v67
    v_exp_f32 v71, v71
    v_mfma_f32_32x32x16_bf16 v[48:63], v[28:31], v[8:11], 0
    v_exp_f32 v72, v72
    v_cvt_pk_bf16_f32 v90, v68, v69
    v_exp_f32 v73, v73
    v_mfma_f32_32x32x8bf16_1k v[48:63], v[26:27], v[16:17], v[48:63]
    v_exp_f32 v74, v74
    v_cvt_pk_bf16_f32 v91, v70, v71
    v_exp_f32 v75, v75
    v_exp_f32 v76, v76
    v_cvt_pk_bf16_f32 v92, v72, v73
    v_exp_f32 v77, v77
    v_exp_f32 v78, v78
    v_cvt_pk_bf16_f32 v93, v74, v75
    v_exp_f32 v79, v79
    v_cvt_pk_bf16_f32 v94, v76, v77
    v_cvt_pk_bf16_f32 v95, v78, v79
    s_setprio 0
    ds_read_b128 v[40:43], v4 offset:5120
    ds_read_b128 v[44:47], v4 offset:6144
    v_exp_f32 v48, v48
    v_mfma_f32_32x32x16_bf16 v[64:79], v[28:31], v[12:15], 0
    v_exp_f32 v49, v49
    v_exp_f32 v50, v50
    v_exp_f32 v51, v51
    v_exp_f32 v52, v52
    v_mfma_f32_32x32x8bf16_1k v[64:79], v[26:27], v[18:19], v[64:79]
    v_cvt_pk_bf16_f32 v80, v48, v49
    v_exp_f32 v53, v53
    v_exp_f32 v54, v54
    v_cvt_pk_bf16_f32 v81, v50, v51
    v_exp_f32 v55, v55
    v_mfma_f32_32x32x16_bf16 v[112:127], v[32:35], v[88:91], v[112:127]
    v_exp_f32 v56, v56
    v_cvt_pk_bf16_f32 v82, v52, v53
    v_exp_f32 v57, v57
    v_exp_f32 v58, v58
    v_cvt_pk_bf16_f32 v83, v54, v55
    v_mfma_f32_32x32x16_bf16 v[112:127], v[36:39], v[92:95], v[112:127]
    v_exp_f32 v59, v59
    v_exp_f32 v60, v60
    v_cvt_pk_bf16_f32 v84, v56, v57
    v_exp_f32 v61, v61
    v_exp_f32 v62, v62
    v_cvt_pk_bf16_f32 v85, v58, v59
    v_exp_f32 v63, v63
    v_cvt_pk_bf16_f32 v86, v60, v61
    v_cvt_pk_bf16_f32 v87, v62, v63
    s_cmp_lt_u32 s74, 5
    s_cbranch_scc1 L_bw_26
    s_waitcnt vmcnt(5)
L_bw_26:
    s_waitcnt lgkmcnt(0)
    s_barrier
    s_setprio 3
    ds_read_b128 v[20:23], v4 offset:14336
    ds_read_b64 v[24:25], v5 offset:14336
    s_cmp_lt_u32 s74, 5
    s_cbranch_scc1 L_kd_27
    s_add_u32 m0, s84, 102400
    s_add_u32 s83, s82, 0
    buffer_load_dwordx4 v6, s[8:11], s83 offen lds
    s_add_u32 m0, s84, 105472
    s_add_u32 s83, s82, 3072
    buffer_load_dwordx4 v6, s[8:11], s83 offen lds
    s_add_u32 m0, s84, 108544
    s_add_u32 s83, s82, 6144
    buffer_load_dwordx4 v6, s[8:11], s83 offen lds
    s_add_u32 m0, s84, 111616
    s_add_u32 s83, s82, 9216
    buffer_load_dwordx4 v6, s[8:11], s83 offen lds
    s_add_u32 m0, s85, 102400
    s_sub_u32 s83, s82, s84
    s_add_u32 s83, s83, s85
    buffer_load_dwordx4 v6, s[8:11], s83 offen lds
    s_add_u32 s82, s82, 14336
L_kd_27:
    s_bitcmp1_b32 s81, s80
    s_cbranch_scc0 L_hk_ret0
    s_mov_b32 s39, 0
    s_branch L_hk_entry
L_hk_ret0:
    v_exp_f32 v64, v64
    v_exp_f32 v65, v65
    v_mfma_f32_32x32x16_bf16 v[96:111], v[40:43], v[80:83], v[96:111]
    v_exp_f32 v66, v66
    v_exp_f32 v67, v67
    v_exp_f32 v68, v68
    v_cvt_pk_bf16_f32 v88, v64, v65
    v_mfma_f32_32x32x16_bf16 v[96:111], v[44:47], v[84:87], v[96:111]
    v_exp_f32 v69, v69
    v_exp_f32 v70, v70
    v_cvt_pk_bf16_f32 v89, v66, v67
    v_exp_f32 v71, v71
    s_waitcnt lgkmcnt(0)
    v_mfma_f32_32x32x16_bf16 v[48:63], v[20:23], v[8:11], 0
    v_exp_f32 v72, v72
    v_cvt_pk_bf16_f32 v90, v68, v69
    v_exp_f32 v73, v73
    v_mfma_f32_32x32x8bf16_1k v[48:63], v[24:25], v[16:17], v[48:63]
    v_exp_f32 v74, v74
    v_cvt_pk_bf16_f32 v91, v70, v71
    v_exp_f32 v75, v75
    v_exp_f32 v76, v76
    v_cvt_pk_bf16_f32 v92, v72, v73
    v_exp_f32 v77, v77
    v_exp_f32 v78, v78
    v_cvt_pk_bf16_f32 v93, v74, v75
    v_exp_f32 v79, v79
    v_cvt_pk_bf16_f32 v94, v76, v77
    v_cvt_pk_bf16_f32 v95, v78, v79
    s_add_u32 s80, s80, 1
    s_cmp_eq_u32 s80, 16
    s_cbranch_scc1 L_at_done
    s_setprio 2
    ds_read_b128 v[32:35], v4 offset:15872
    ds_read_b128 v[36:39], v4 offset:16896
    ds_read_b128 v[28:31], v4 offset:17920
    ds_read_b64 v[26:27], v5 offset:17920
    v_exp_f32 v48, v48
    v_mfma_f32_32x32x16_bf16 v[64:79], v[20:23], v[12:15], 0
    v_exp_f32 v49, v49
    v_exp_f32 v50, v50
    v_exp_f32 v51, v51
    v_exp_f32 v52, v52
    v_mfma_f32_32x32x8bf16_1k v[64:79], v[24:25], v[18:19], v[64:79]
    v_cvt_pk_bf16_f32 v80, v48, v49
    v_exp_f32 v53, v53
    v_exp_f32 v54, v54
    v_cvt_pk_bf16_f32 v81, v50, v51
    v_exp_f32 v55, v55
    v_mfma_f32_32x32x16_bf16 v[112:127], v[40:43], v[88:91], v[112:127]
    v_exp_f32 v56, v56
    v_cvt_pk_bf16_f32 v82, v52, v53
    v_exp_f32 v57, v57
    v_exp_f32 v58, v58
    v_cvt_pk_bf16_f32 v83, v54, v55
    v_mfma_f32_32x32x16_bf16 v[112:127], v[44:47], v[92:95], v[112:127]
    v_exp_f32 v59, v59
    v_exp_f32 v60, v60
    v_cvt_pk_bf16_f32 v84, v56, v57
    v_exp_f32 v61, v61
    v_exp_f32 v62, v62
    v_cvt_pk_bf16_f32 v85, v58, v59
    v_exp_f32 v63, v63
    v_cvt_pk_bf16_f32 v86, v60, v61
    v_cvt_pk_bf16_f32 v87, v62, v63
    s_setprio 1
    v_exp_f32 v64, v64
    v_exp_f32 v65, v65
    s_waitcnt lgkmcnt(0)
    v_mfma_f32_32x32x16_bf16 v[96:111], v[32:35], v[80:83], v[96:111]
    v_exp_f32 v66, v66
    v_exp_f32 v67, v67
    v_exp_f32 v68, v68
    v_cvt_pk_bf16_f32 v88, v64, v65
    v_mfma_f32_32x32x16_bf16 v[96:111], v[36:39], v[84:87], v[96:111]
    v_exp_f32 v69, v69
    v_exp_f32 v70, v70
    v_cvt_pk_bf16_f32 v89, v66, v67
    v_exp_f32 v71, v71
    v_mfma_f32_32x32x16_bf16 v[48:63], v[28:31], v[8:11], 0
    v_exp_f32 v72, v72
    v_cvt_pk_bf16_f32 v90, v68, v69
    v_exp_f32 v73, v73
    v_mfma_f32_32x32x8bf16_1k v[48:63], v[26:27], v[16:17], v[48:63]
    v_exp_f32 v74, v74
    v_cvt_pk_bf16_f32 v91, v70, v71
    v_exp_f32 v75, v75
    v_exp_f32 v76, v76
    v_cvt_pk_bf16_f32 v92, v72, v73
    v_exp_f32 v77, v77
    v_exp_f32 v78, v78
    v_cvt_pk_bf16_f32 v93, v74, v75
    v_exp_f32 v79, v79
    v_cvt_pk_bf16_f32 v94, v76, v77
    v_cvt_pk_bf16_f32 v95, v78, v79
    s_setprio 0
    ds_read_b128 v[40:43], v4 offset:19456
    ds_read_b128 v[44:47], v4 offset:20480
    v_exp_f32 v48, v48
    v_mfma_f32_32x32x16_bf16 v[64:79], v[28:31], v[12:15], 0
    v_exp_f32 v49, v49
    v_exp_f32 v50, v50
    v_exp_f32 v51, v51
    v_exp_f32 v52, v52
    v_mfma_f32_32x32x8bf16_1k v[64:79], v[26:27], v[18:19], v[64:79]
    v_cvt_pk_bf16_f32 v80, v48, v49
    v_exp_f32 v53, v53
    v_exp_f32 v54, v54
    v_cvt_pk_bf16_f32 v81, v50, v51
    v_exp_f32 v55, v55
    v_mfma_f32_32x32x16_bf16 v[112:127], v[32:35], v[88:91], v[112:127]
    v_exp_f32 v56, v56
    v_cvt_pk_bf16_f32 v82, v52, v53
    v_exp_f32 v57, v57
    v_exp_f32 v58, v58
    v_cvt_pk_bf16_f32 v83, v54, v55
    v_mfma_f32_32x32x16_bf16 v[112:127], v[36:39], v[92:95], v[112:127]
    v_exp_f32 v59, v59
    v_exp_f32 v60, v60
    v_cvt_pk_bf16_f32 v84, v56, v57
    v_exp_f32 v61, v61
    v_exp_f32 v62, v62
    v_cvt_pk_bf16_f32 v85, v58, v59
    v_exp_f32 v63, v63
    v_cvt_pk_bf16_f32 v86, v60, v61
    v_cvt_pk_bf16_f32 v87, v62, v63
    s_cmp_lt_u32 s74, 5
    s_cbranch_scc1 L_bw_28
    s_waitcnt vmcnt(5)
L_bw_28:
    s_waitcnt lgkmcnt(0)
    s_barrier
    s_setprio 3
    ds_read_b128 v[20:23], v4 offset:28672
    ds_read_b64 v[24:25], v5 offset:28672
    s_cmp_lt_u32 s74, 5
    s_cbranch_scc1 L_kd_29
    s_add_u32 m0, s84, 116736
    s_add_u32 s83, s82, 0
    buffer_load_dwordx4 v6, s[8:11], s83 offen lds
    s_add_u32 m0, s84, 119808
    s_add_u32 s83, s82, 3072
    buffer_load_dwordx4 v6, s[8:11], s83 offen lds
    s_add_u32 m0, s84, 122880
    s_add_u32 s83, s82, 6144
    buffer_load_dwordx4 v6, s[8:11], s83 offen lds
    s_add_u32 m0, s84, 125952
    s_add_u32 s83, s82, 9216
    buffer_load_dwordx4 v6, s[8:11], s83 offen lds
    s_add_u32 m0, s85, 116736
    s_sub_u32 s83, s82, s84
    s_add_u32 s83, s83, s85
    buffer_load_dwordx4 v6, s[8:11], s83 offen lds
    s_add_u32 s82, s82, 14336
L_kd_29:
    s_bitcmp1_b32 s81, s80
    s_cbranch_scc0 L_hk_ret1
    s_mov_b32 s39, 1
    s_branch L_hk_entry
L_hk_ret1:
    v_exp_f32 v64, v64
    v_exp_f32 v65, v65
    v_mfma_f32_32x32x16_bf16 v[96:111], v[40:43], v[80:83], v[96:111]
    v_exp_f32 v66, v66
    v_exp_f32 v67, v67
    v_exp_f32 v68, v68
    v_cvt_pk_bf16_f32 v88, v64, v65
    v_mfma_f32_32x32x16_bf16 v[96:111], v[44:47], v[84:87], v[96:111]
    v_exp_f32 v69, v69
    v_exp_f32 v70, v70
    v_cvt_pk_bf16_f32 v89, v66, v67
    v_exp_f32 v71, v71
    s_waitcnt lgkmcnt(0)
    v_mfma_f32_32x32x16_bf16 v[48:63], v[20:23], v[8:11], 0
    v_exp_f32 v72, v72
    v_cvt_pk_bf16_f32 v90, v68, v69
    v_exp_f32 v73, v73
    v_mfma_f32_32x32x8bf16_1k v[48:63], v[24:25], v[16:17], v[48:63]
    v_exp_f32 v74, v74
    v_cvt_pk_bf16_f32 v91, v70, v71
    v_exp_f32 v75, v75
    v_exp_f32 v76, v76
    v_cvt_pk_bf16_f32 v92, v72, v73
    v_exp_f32 v77, v77
    v_exp_f32 v78, v78
    v_cvt_pk_bf16_f32 v93, v74, v75
    v_exp_f32 v79, v79
    v_cvt_pk_bf16_f32 v94, v76, v77
    v_cvt_pk_bf16_f32 v95, v78, v79
    s_add_u32 s80, s80, 1
    s_cmp_eq_u32 s80, 16
    s_cbranch_scc1 L_at_done
    s_setprio 2
    ds_read_b128 v[32:35], v4 offset:30208
    ds_read_b128 v[36:39], v4 offset:31232
    ds_read_b128 v[28:31], v4 offset:32256
    ds_read_b64 v[26:27], v5 offset:32256
    v_exp_f32 v48, v48
    v_mfma_f32_32x32x16_bf16 v[64:79], v[20:23], v[12:15], 0
    v_exp_f32 v49, v49
    v_exp_f32 v50, v50
    v_exp_f32 v51, v51
    v_exp_f32 v52, v52
    v_mfma_f32_32x32x8bf16_1k v[64:79], v[24:25], v[18:19], v[64:79]
    v_cvt_pk_bf16_f32 v80, v48, v49
    v_exp_f32 v53, v53
    v_exp_f32 v54, v54
    v_cvt_pk_bf16_f32 v81, v50, v51
    v_exp_f32 v55, v55
    v_mfma_f32_32x32x16_bf16 v[112:127], v[40:43], v[88:91], v[112:127]
    v_exp_f32 v56, v56
    v_cvt_pk_bf16_f32 v82, v52, v53
    v_exp_f32 v57, v57
    v_exp_f32 v58, v58
    v_cvt_pk_bf16_f32 v83, v54, v55
    v_mfma_f32_32x32x16_bf16 v[112:127], v[44:47], v[92:95], v[112:127]
    v_exp_f32 v59, v59
    v_exp_f32 v60, v60
    v_cvt_pk_bf16_f32 v84, v56, v57
    v_exp_f32 v61, v61
    v_exp_f32 v62, v62
    v_cvt_pk_bf16_f32 v85, v58, v59
    v_exp_f32 v63, v63
    v_cvt_pk_bf16_f32 v86, v60, v61
    v_cvt_pk_bf16_f32 v87, v62, v63
    s_setprio 1
    v_exp_f32 v64, v64
    v_exp_f32 v65, v65
    s_waitcnt lgkmcnt(0)
    v_mfma_f32_32x32x16_bf16 v[96:111], v[32:35], v[80:83], v[96:111]
    v_exp_f32 v66, v66
    v_exp_f32 v67, v67
    v_exp_f32 v68, v68
    v_cvt_pk_bf16_f32 v88, v64, v65
    v_mfma_f32_32x32x16_bf16 v[96:111], v[36:39], v[84:87], v[96:111]
    v_exp_f32 v69, v69
    v_exp_f32 v70, v70
    v_cvt_pk_bf16_f32 v89, v66, v67
    v_exp_f32 v71, v71
    v_mfma_f32_32x32x16_bf16 v[48:63], v[28:31], v[8:11], 0
    v_exp_f32 v72, v72
    v_cvt_pk_bf16_f32 v90, v68, v69
    v_exp_f32 v73, v73
    v_mfma_f32_32x32x8bf16_1k v[48:63], v[26:27], v[16:17], v[48:63]
    v_exp_f32 v74, v74
    v_cvt_pk_bf16_f32 v91, v70, v71
    v_exp_f32 v75, v75
    v_exp_f32 v76, v76
    v_cvt_pk_bf16_f32 v92, v72, v73
    v_exp_f32 v77, v77
    v_exp_f32 v78, v78
    v_cvt_pk_bf16_f32 v93, v74, v75
    v_exp_f32 v79, v79
    v_cvt_pk_bf16_f32 v94, v76, v77
    v_cvt_pk_bf16_f32 v95, v78, v79
    s_setprio 0
    ds_read_b128 v[40:43], v4 offset:33792
    ds_read_b128 v[44:47], v4 offset:34816
    v_exp_f32 v48, v48
    v_mfma_f32_32x32x16_bf16 v[64:79], v[28:31], v[12:15], 0
    v_exp_f32 v49, v49
    v_exp_f32 v50, v50
    v_exp_f32 v51, v51
    v_exp_f32 v52, v52
    v_mfma_f32_32x32x8bf16_1k v[64:79], v[26:27], v[18:19], v[64:79]
    v_cvt_pk_bf16_f32 v80, v48, v49
    v_exp_f32 v53, v53
    v_exp_f32 v54, v54
    v_cvt_pk_bf16_f32 v81, v50, v51
    v_exp_f32 v55, v55
    v_mfma_f32_32x32x16_bf16 v[112:127], v[32:35], v[88:91], v[112:127]
    v_exp_f32 v56, v56
    v_cvt_pk_bf16_f32 v82, v52, v53
    v_exp_f32 v57, v57
    v_exp_f32 v58, v58
    v_cvt_pk_bf16_f32 v83, v54, v55
    v_mfma_f32_32x32x16_bf16 v[112:127], v[36:39], v[92:95], v[112:127]
    v_exp_f32 v59, v59
    v_exp_f32 v60, v60
    v_cvt_pk_bf16_f32 v84, v56, v57
    v_exp_f32 v61, v61
    v_exp_f32 v62, v62
    v_cvt_pk_bf16_f32 v85, v58, v59
    v_exp_f32 v63, v63
    v_cvt_pk_bf16_f32 v86, v60, v61
    v_cvt_pk_bf16_f32 v87, v62, v63
    s_cmp_lt_u32 s74, 5
    s_cbranch_scc1 L_bw_30
    s_waitcnt vmcnt(5)
L_bw_30:
    s_waitcnt lgkmcnt(0)
    s_barrier
    s_setprio 3
    ds_read_b128 v[20:23], v4 offset:0
    ds_read_b64 v[24:25], v5 offset:0
    s_cmp_lt_u32 s74, 5
    s_cbranch_scc1 L_kd_31
    s_add_u32 m0, s84, 131072
    s_add_u32 s83, s82, 0
    buffer_load_dwordx4 v6, s[8:11], s83 offen lds
    s_add_u32 m0, s84, 134144
    s_add_u32 s83, s82, 3072
    buffer_load_dwordx4 v6, s[8:11], s83 offen lds
    s_add_u32 m0, s84, 137216
    s_add_u32 s83, s82, 6144
    buffer_load_dwordx4 v6, s[8:11], s83 offen lds
    s_add_u32 m0, s84, 140288
    s_add_u32 s83, s82, 9216
    buffer_load_dwordx4 v6, s[8:11], s83 offen lds
    s_add_u32 m0, s85, 131072
    s_sub_u32 s83, s82, s84
    s_add_u32 s83, s83, s85
    buffer_load_dwordx4 v6, s[8:11], s83 offen lds
    s_add_u32 s82, s82, 14336
L_kd_31:
    s_bitcmp1_b32 s81, s80
    s_cbranch_scc0 L_hk_ret2
    s_mov_b32 s39, 2
    s_branch L_hk_entry
L_hk_ret2:
    v_exp_f32 v64, v64
    v_exp_f32 v65, v65
    v_mfma_f32_32x32x16_bf16 v[96:111], v[40:43], v[80:83], v[96:111]
    v_exp_f32 v66, v66
    v_exp_f32 v67, v67
    v_exp_f32 v68, v68
    v_cvt_pk_bf16_f32 v88, v64, v65
    v_mfma_f32_32x32x16_bf16 v[96:111], v[44:47], v[84:87], v[96:111]
    v_exp_f32 v69, v69
    v_exp_f32 v70, v70
    v_cvt_pk_bf16_f32 v89, v66, v67
    v_exp_f32 v71, v71
    s_waitcnt lgkmcnt(0)
    v_mfma_f32_32x32x16_bf16 v[48:63], v[20:23], v[8:11], 0
    v_exp_f32 v72, v72
    v_cvt_pk_bf16_f32 v90, v68, v69
    v_exp_f32 v73, v73
    v_mfma_f32_32x32x8bf16_1k v[48:63], v[24:25], v[16:17], v[48:63]
    v_exp_f32 v74, v74
    v_cvt_pk_bf16_f32 v91, v70, v71
    v_exp_f32 v75, v75
    v_exp_f32 v76, v76
    v_cvt_pk_bf16_f32 v92, v72, v73
    v_exp_f32 v77, v77
    v_exp_f32 v78, v78
    v_cvt_pk_bf16_f32 v93, v74, v75
    v_exp_f32 v79, v79
    v_cvt_pk_bf16_f32 v94, v76, v77
    v_cvt_pk_bf16_f32 v95, v78, v79
    s_add_u32 s80, s80, 1
    s_cmp_lt_u32 s80, 16
    s_cbranch_scc1 L_at_loop
L_at_done:
    s_setprio 0
    s_nop 1
    v_mfma_f32_32x32x16_bf16 v[112:127], v[40:43], v[88:91], v[112:127]
    v_mfma_f32_32x32x16_bf16 v[112:127], v[44:47], v[92:95], v[112:127]
    s_waitcnt vmcnt(0)
    s_barrier
    s_mul_i32 s24, s75, 6144
    s_add_u32 s24, s24, 102400
    v_lshl_add_u32 v7, v1, 4, s24
    s_cmp_eq_u32 s76, 0
    s_cbranch_scc1 L_ae_rd
    s_nop 7
    ds_write_b128 v7, v[96:99] offset:0
    ds_write_b128 v7, v[112:115] offset:3072
    ds_write_b128 v7, v[100:103] offset:1024
    ds_write_b128 v7, v[116:119] offset:4096
    ds_write_b128 v7, v[104:107] offset:2048
    ds_write_b128 v7, v[120:123] offset:5120
    s_waitcnt lgkmcnt(0)
L_ae_rd:
    s_barrier
    s_cmp_eq_u32 s76, 0
    s_cbranch_scc0 L_ae_done
    ds_read_b128 v[48:51], v7 offset:0
    ds_read_b128 v[52:55], v7 offset:1024
    ds_read_b128 v[56:59], v7 offset:2048
    ds_read_b128 v[60:63], v7 offset:3072
    ds_read_b128 v[64:67], v7 offset:4096
    ds_read_b128 v[68:71], v7 offset:5120
    s_waitcnt lgkmcnt(0)
    v_add_f32 v96, v96, v48
    v_add_f32 v112, v112, v60
    v_add_f32 v97, v97, v49
    v_add_f32 v113, v113, v61
    v_add_f32 v98, v98, v50
    v_add_f32 v114, v114, v62
    v_add_f32 v99, v99, v51
    v_add_f32 v115, v115, v63
    v_add_f32 v100, v100, v52
    v_add_f32 v116, v116, v64
    v_add_f32 v101, v101, v53
    v_add_f32 v117, v117, v65
    v_add_f32 v102, v102, v54
    v_add_f32 v118, v118, v66
    v_add_f32 v103, v103, v55
    v_add_f32 v119, v119, v67
    v_add_f32 v104, v104, v56
    v_add_f32 v120, v120, v68
    v_add_f32 v105, v105, v57
    v_add_f32 v121, v121, v69
    v_add_f32 v106, v106, v58
    v_add_f32 v122, v122, v70
    v_add_f32 v107, v107, v59
    v_add_f32 v123, v123, v71
    v_mov_b32 v20, v104
    v_mov_b32 v21, v104
    v_mov_b32 v22, v120
    v_mov_b32 v23, v120
    s_nop 1
    v_permlane32_swap_b32 v20, v21
    v_permlane32_swap_b32 v22, v23
    v_rcp_f32 v21, v21
    v_rcp_f32 v23, v23
    s_nop 0
    v_mul_f32 v96, v96, v21
    v_mul_f32 v112, v112, v23
    v_mul_f32 v97, v97, v21
    v_mul_f32 v113, v113, v23
    v_mul_f32 v98, v98, v21
    v_mul_f32 v114, v114, v23
    v_mul_f32 v99, v99, v21
    v_mul_f32 v115, v115, v23
    v_mul_f32 v100, v100, v21
    v_mul_f32 v116, v116, v23
    v_mul_f32 v101, v101, v21
    v_mul_f32 v117, v117, v23
    v_mul_f32 v102, v102, v21
    v_mul_f32 v118, v118, v23
    v_mul_f32 v103, v103, v21
    v_mul_f32 v119, v119, v23
    v_mul_f32 v104, v104, v21
    v_mul_f32 v120, v120, v23
    v_mul_f32 v105, v105, v21
    v_mul_f32 v121, v121, v23
    v_mul_f32 v106, v106, v21
    v_mul_f32 v122, v122, v23
    v_mul_f32 v107, v107, v21
    v_mul_f32 v123, v123, v23
    v_cvt_pk_bf16_f32 v24, v96, v97
    v_cvt_pk_bf16_f32 v28, v112, v113
    v_cvt_pk_bf16_f32 v25, v98, v99
    v_cvt_pk_bf16_f32 v29, v114, v115
    v_cvt_pk_bf16_f32 v26, v100, v101
    v_cvt_pk_bf16_f32 v30, v116, v117
    v_cvt_pk_bf16_f32 v27, v102, v103
    v_cvt_pk_bf16_f32 v31, v118, v119
    v_cvt_pk_bf16_f32 v32, v104, v105
    v_cvt_pk_bf16_f32 v33, v106, v107
    v_cvt_pk_bf16_f32 v34, v120, v121
    v_cvt_pk_bf16_f32 v35, v122, v123
    v_lshrrev_b32 v36, 5, v1
    v_bfe_u32 v37, v1, 4, 1
    v_lshl_add_u32 v38, v37, 1, v36
    v_mul_u32_u24 v38, 33024, v38
    v_lshl_add_u32 v38, v2, 4, v38
    v_mul_u32_u24 v39, 33024, v37
    v_lshl_add_u32 v39, v2, 4, v39
    v_mov_b32 v40, 0x7fffffff
    v_cmp_eq_u32 vcc, 0, v36
    s_mul_i32 s24, s73, 330240
    s_lshl_b32 s25, s78, 8
    s_add_u32 s24, s24, s25
    v_cndmask_b32 v39, v40, v39, vcc
    s_add_u32 s24, s24, 13631616
    s_add_u32 s25, s24, 132096
    s_add_u32 s26, s24, 264192
    buffer_store_dwordx4 v[24:27], v38, s[8:11], s24 offen sc1
    buffer_store_dwordx4 v[28:31], v38, s[8:11], s25 offen sc1
    buffer_store_dwordx4 v[32:35], v39, s[8:11], s26 offen sc1
    s_mul_i32 s25, s78, 32
    s_lshl_b32 s29, s73, 2
    s_add_u32 s25, s25, s29
    s_add_u32 s25, s25, 32768
    s_waitcnt vmcnt(0)
    v_mov_b32 v240, s79
    v_mov_b32 v241, 0
    s_mov_b64 exec, 1
    s_cmp_eq_u32 s100, 0
    s_cbranch_scc1 L_sv_32
    buffer_store_dword v240, v241, s[8:11], s25 offen
    s_branch L_sv_33
L_sv_32:
    buffer_store_dword v240, v241, s[8:11], s25 offen sc1
L_sv_33:
    s_mov_b64 exec, -1
L_ae_done:
    s_cmp_ge_u32 s74, 4
    s_cbranch_scc1 L_ch_loader
    v_mul_u32_u24 v4, 33024, v3
    v_lshl_add_u32 v4, v2, 4, v4
    s_lshl_b32 s24, s78, 8
    s_add_u32 s24, s24, 128
    v_add_u32 v4, s24, v4
    v_lshlrev_b32 v7, 4, v3
    v_add_u32 v7, 145408, v7
    v_lshlrev_b32 v5, 4, v1
    v_add_u32 v6, 51200, v5
    s_lshr_b32 s26, s73, 1
    s_mul_i32 s26, s26, 5
    s_and_b32 s27, s73, 1
    s_lshl_b32 s28, s27, 1
    s_add_u32 s28, s28, s26
    s_mul_i32 s97, s28, 132096
    s_add_u32 s26, s26, 4
    s_mul_i32 s96, s26, 132096
    s_lshl_b32 s27, s27, 3
    s_add_u32 s96, s96, s27
    v_mov_b32 v244, 150656
    ds_read_b128 v[164:167], v244
    ds_read_b32 v168, v244 offset:16
    s_waitcnt vmcnt(0)
    v_lshlrev_b32 v8, 16, v208
    v_and_b32 v9, 0xffff0000, v208
    v_lshlrev_b32 v10, 16, v209
    v_and_b32 v11, 0xffff0000, v209
    v_lshlrev_b32 v12, 16, v210
    v_and_b32 v13, 0xffff0000, v210
    v_lshlrev_b32 v14, 16, v211
    v_and_b32 v15, 0xffff0000, v211
    v_lshlrev_b32 v16, 16, v212
    v_and_b32 v17, 0xffff0000, v212
    v_lshlrev_b32 v18, 16, v213
    v_and_b32 v19, 0xffff0000, v213
    v_lshlrev_b32 v20, 16, v214
    v_and_b32 v21, 0xffff0000, v214
    v_lshlrev_b32 v22, 16, v215
    v_and_b32 v23, 0xffff0000, v215
    v_lshlrev_b32 v24, 16, v216
    v_and_b32 v25, 0xffff0000, v216
    v_lshlrev_b32 v26, 16, v217
    v_and_b32 v27, 0xffff0000, v217
    s_waitcnt lgkmcnt(0)
    v_readfirstlane_b32 s91, v164
    v_readfirstlane_b32 s92, v165
    v_readfirstlane_b32 s93, v166
    v_readfirstlane_b32 s94, v167
    v_readfirstlane_b32 s95, v168
    s_waitcnt vmcnt(0)
    s_barrier
    s_mul_i32 s24, s78, 32
    s_add_u32 s24, s24, 32768
    v_lshlrev_b32 v244, 2, v1
    s_mov_b64 exec, 0xff
    s_mov_b32 s101, 0x40000
L_poll_34:
    buffer_load_dword v245, v244, s[8:11], s24 offen sc1
    s_waitcnt vmcnt(0)
    v_cmp_ne_u32 vcc, s79, v245
    s_sub_u32 s101, s101, 1
    s_cmp_eq_u64 vcc, 0
    s_cbranch_scc1 L_polld_35
    s_cmp_lg_u32 s101, 0
    s_cbranch_scc1 L_poll_34
L_polld_35:
    s_mov_b64 exec, -1
    s_add_u32 s12, s68, 13631488
    s_addc_u32 s13, s69, 0
    s_mov_b32 s14, 2641920
    s_mov_b32 s15, 0x00020000
    s_mov_b32 s81, 0
    s_mov_b32 s82, 0
    s_mov_b32 s83, 0
    s_mov_b32 s84, 0
    s_mov_b32 s88, 0
L_g_entry:
    buffer_load_dwordx4 v[164:167], v4, s[12:15], s81 offen sc1
    s_add_u32 s81, s81, 132096
    buffer_load_dwordx4 v[168:171], v4, s[12:15], s81 offen sc1
    s_add_u32 s81, s81, 132096
    buffer_load_dwordx4 v[172:175], v4, s[12:15], s81 offen sc1
    s_add_u32 s81, s81, 132096
    buffer_load_dwordx4 v[176:179], v4, s[12:15], s81 offen sc1
    s_add_u32 s81, s81, 132096
    buffer_load_dwordx4 v[180:183], v4, s[12:15], s81 offen sc1
    s_add_u32 s81, s81, 132096
    s_add_u32 s81, s81, s82
    buffer_load_dwordx4 v[184:187], v4, s[12:15], s81 offen sc1
    s_add_u32 s81, s81, 132096
    buffer_load_dwordx4 v[188:191], v4, s[12:15], s81 offen sc1
    s_add_u32 s81, s81, 132096
    buffer_load_dwordx4 v[192:195], v4, s[12:15], s81 offen sc1
    s_add_u32 s81, s81, 132096
    ds_read_b128 v[104:107], v5 offset:0
    ds_read_b128 v[108:111], v5 offset:1024
    ds_read_b128 v[112:115], v5 offset:2048
    ds_read_b128 v[116:119], v5 offset:3072
    ds_read_b128 v[120:123], v5 offset:4096
    ds_read_b128 v[124:127], v5 offset:5120
    ds_read_b128 v[128:131], v5 offset:6144
    ds_read_b128 v[132:135], v5 offset:7168
    ds_read_b128 v[136:139], v5 offset:8192
    ds_read_b128 v[140:143], v5 offset:9216
    v_mov_b64 v[48:49], 0
    v_mov_b64 v[50:51], 0
    v_mov_b64 v[52:53], 0
    v_mov_b64 v[54:55], 0
    v_mov_b64 v[56:57], 0
    v_mov_b64 v[58:59], 0
    v_mov_b64 v[60:61], 0
    v_mov_b64 v[62:63], 0
    v_mov_b64 v[64:65], 0
    v_mov_b64 v[66:67], 0
    s_waitcnt vmcnt(7) lgkmcnt(5)
    ds_read_b128 v[144:147], v5 offset:10240
    ds_read_b128 v[148:151], v5 offset:11264
    ds_read_b128 v[152:155], v5 offset:12288
    ds_read_b128 v[156:159], v5 offset:13312
    ds_read_b128 v[160:163], v5 offset:14336
    v_mfma_f32_16x16x32_bf16 v[48:51], v[104:107], v[164:167], v[48:51]
    v_mfma_f32_16x16x32_bf16 v[52:55], v[108:111], v[164:167], v[52:55]
    v_mfma_f32_16x16x32_bf16 v[56:59], v[112:115], v[164:167], v[56:59]
    v_mfma_f32_16x16x32_bf16 v[60:63], v[116:119], v[164:167], v[60:63]
    v_mfma_f32_16x16x32_bf16 v[64:67], v[120:123], v[164:167], v[64:67]
    buffer_load_dwordx4 v[196:199], v4, s[12:15], s81 offen sc1
    s_add_u32 s81, s81, 132096
    s_waitcnt vmcnt(7) lgkmcnt(5)
    ds_read_b128 v[104:107], v5 offset:15360
    ds_read_b128 v[108:111], v5 offset:16384
    ds_read_b128 v[112:115], v5 offset:17408
    ds_read_b128 v[116:119], v5 offset:18432
    ds_read_b128 v[120:123], v5 offset:19456
    v_mfma_f32_16x16x32_bf16 v[48:51], v[124:127], v[168:171], v[48:51]
    v_mfma_f32_16x16x32_bf16 v[52:55], v[128:131], v[168:171], v[52:55]
    v_mfma_f32_16x16x32_bf16 v[56:59], v[132:135], v[168:171], v[56:59]
    v_mfma_f32_16x16x32_bf16 v[60:63], v[136:139], v[168:171], v[60:63]
    v_mfma_f32_16x16x32_bf16 v[64:67], v[140:143], v[168:171], v[64:67]
    buffer_load_dwordx4 v[200:203], v4, s[12:15], s81 offen sc1
    s_add_u32 s81, s81, 132096
    s_add_u32 s81, s81, s83
    s_waitcnt vmcnt(7) lgkmcnt(5)
    ds_read_b128 v[124:127], v5 offset:20480
    ds_read_b128 v[128:131], v5 offset:21504
    ds_read_b128 v[132:135], v5 offset:22528
    ds_read_b128 v[136:139], v5 offset:23552
    ds_read_b128 v[140:143], v5 offset:24576
    v_mfma_f32_16x16x32_bf16 v[48:51], v[144:147], v[172:175], v[48:51]
    v_mfma_f32_16x16x32_bf16 v[52:55], v[148:151], v[172:175], v[52:55]
    v_mfma_f32_16x16x32_bf16 v[56:59], v[152:155], v[172:175], v[56:59]
    v_mfma_f32_16x16x32_bf16 v[60:63], v[156:159], v[172:175], v[60:63]
    v_mfma_f32_16x16x32_bf16 v[64:67], v[160:163], v[172:175], v[64:67]
    buffer_load_dwordx4 v[204:207], v4, s[12:15], s81 offen sc1
    s_add_u32 s81, s81, 132096
    s_waitcnt vmcnt(7) lgkmcnt(5)
    ds_read_b128 v[144:147], v5 offset:25600
    ds_read_b128 v[148:151], v5 offset:26624
    ds_read_b128 v[152:155], v5 offset:27648
    ds_read_b128 v[156:159], v5 offset:28672
    ds_read_b128 v[160:163], v5 offset:29696
    v_mfma_f32_16x16x32_bf16 v[48:51], v[104:107], v[176:179], v[48:51]
    v_mfma_f32_16x16x32_bf16 v[52:55], v[108:111], v[176:179], v[52:55]
    v_mfma_f32_16x16x32_bf16 v[56:59], v[112:115], v[176:179], v[56:59]
    v_mfma_f32_16x16x32_bf16 v[60:63], v[116:119], v[176:179], v[60:63]
    v_mfma_f32_16x16x32_bf16 v[64:67], v[120:123], v[176:179], v[64:67]
    buffer_load_dwordx4 v[208:211], v4, s[12:15], s81 offen sc1
    s_add_u32 s81, s81, 132096
    s_waitcnt vmcnt(7) lgkmcnt(5)
    ds_read_b128 v[104:107], v5 offset:30720
    ds_read_b128 v[108:111], v5 offset:31744
    ds_read_b128 v[112:115], v5 offset:32768
    ds_read_b128 v[116:119], v5 offset:33792
    ds_read_b128 v[120:123], v5 offset:34816
    v_mfma_f32_16x16x32_bf16 v[48:51], v[124:127], v[180:183], v[48:51]
    v_mfma_f32_16x16x32_bf16 v[52:55], v[128:131], v[180:183], v[52:55]
    v_mfma_f32_16x16x32_bf16 v[56:59], v[132:135], v[180:183], v[56:59]
    v_mfma_f32_16x16x32_bf16 v[60:63], v[136:139], v[180:183], v[60:63]
    v_mfma_f32_16x16x32_bf16 v[64:67], v[140:143], v[180:183], v[64:67]
    buffer_load_dwordx4 v[212:215], v4, s[12:15], s81 offen sc1
    s_add_u32 s81, s81, 132096
    s_waitcnt vmcnt(7) lgkmcnt(5)
    ds_read_b128 v[124:127], v5 offset:35840
    ds_read_b128 v[128:131], v5 offset:36864
    ds_read_b128 v[132:135], v5 offset:37888
    ds_read_b128 v[136:139], v5 offset:38912
    ds_read_b128 v[140:143], v5 offset:39936
    v_mfma_f32_16x16x32_bf16 v[48:51], v[144:147], v[184:187], v[48:51]
    v_mfma_f32_16x16x32_bf16 v[52:55], v[148:151], v[184:187], v[52:55]
    v_mfma_f32_16x16x32_bf16 v[56:59], v[152:155], v[184:187], v[56:59]
    v_mfma_f32_16x16x32_bf16 v[60:63], v[156:159], v[184:187], v[60:63]
    v_mfma_f32_16x16x32_bf16 v[64:67], v[160:163], v[184:187], v[64:67]
    buffer_load_dwordx4 v[216:219], v4, s[12:15], s81 offen sc1
    s_add_u32 s81, s81, 132096
    s_waitcnt vmcnt(7) lgkmcnt(5)
    ds_read_b128 v[144:147], v5 offset:40960
    ds_read_b128 v[148:151], v5 offset:41984
    ds_read_b128 v[152:155], v5 offset:43008
    ds_read_b128 v[156:159], v5 offset:44032
    ds_read_b128 v[160:163], v5 offset:45056
    v_mfma_f32_16x16x32_bf16 v[48:51], v[104:107], v[188:191], v[48:51]
    v_mfma_f32_16x16x32_bf16 v[52:55], v[108:111], v[188:191], v[52:55]
    v_mfma_f32_16x16x32_bf16 v[56:59], v[112:115], v[188:191], v[56:59]
    v_mfma_f32_16x16x32_bf16 v[60:63], v[116:119], v[188:191], v[60:63]
    v_mfma_f32_16x16x32_bf16 v[64:67], v[120:123], v[188:191], v[64:67]
    buffer_load_dwordx4 v[220:223], v4, s[12:15], s81 offen sc1
    s_add_u32 s81, s81, 132096
    s_add_u32 s81, s81, s84
    s_waitcnt vmcnt(7) lgkmcnt(5)
    ds_read_b128 v[104:107], v5 offset:46080
    ds_read_b128 v[108:111], v5 offset:47104
    ds_read_b128 v[112:115], v5 offset:48128
    ds_read_b128 v[116:119], v5 offset:49152
    ds_read_b128 v[120:123], v5 offset:50176
    v_mfma_f32_16x16x32_bf16 v[48:51], v[124:127], v[192:195], v[48:51]
    v_mfma_f32_16x16x32_bf16 v[52:55], v[128:131], v[192:195], v[52:55]
    v_mfma_f32_16x16x32_bf16 v[56:59], v[132:135], v[192:195], v[56:59]
    v_mfma_f32_16x16x32_bf16 v[60:63], v[136:139], v[192:195], v[60:63]
    v_mfma_f32_16x16x32_bf16 v[64:67], v[140:143], v[192:195], v[64:67]
    buffer_load_dwordx4 v[224:227], v4, s[12:15], s81 offen sc1
    s_add_u32 s81, s81, 132096
    s_waitcnt vmcnt(7) lgkmcnt(5)
    ds_read_b128 v[124:127], v6 offset:0
    ds_read_b128 v[128:131], v6 offset:1024
    ds_read_b128 v[132:135], v6 offset:2048
    ds_read_b128 v[136:139], v6 offset:3072
    ds_read_b128 v[140:143], v6 offset:4096
    v_mfma_f32_16x16x32_bf16 v[48:51], v[144:147], v[196:199], v[48:51]
    v_mfma_f32_16x16x32_bf16 v[52:55], v[148:151], v[196:199], v[52:55]
    v_mfma_f32_16x16x32_bf16 v[56:59], v[152:155], v[196:199], v[56:59]
    v_mfma_f32_16x16x32_bf16 v[60:63], v[156:159], v[196:199], v[60:63]
    v_mfma_f32_16x16x32_bf16 v[64:67], v[160:163], v[196:199], v[64:67]
    buffer_load_dwordx4 v[228:231], v4, s[12:15], s81 offen sc1
    s_add_u32 s81, s81, 132096
    s_waitcnt vmcnt(7) lgkmcnt(5)
    ds_read_b128 v[144:147], v6 offset:5120
    ds_read_b128 v[148:151], v6 offset:6144
    ds_read_b128 v[152:155], v6 offset:7168
    ds_read_b128 v[156:159], v6 offset:8192
    ds_read_b128 v[160:163], v6 offset:9216
    v_mfma_f32_16x16x32_bf16 v[48:51], v[104:107], v[200:203], v[48:51]
    v_mfma_f32_16x16x32_bf16 v[52:55], v[108:111], v[200:203], v[52:55]
    v_mfma_f32_16x16x32_bf16 v[56:59], v[112:115], v[200:203], v[56:59]
    v_mfma_f32_16x16x32_bf16 v[60:63], v[116:119], v[200:203], v[60:63]
    v_mfma_f32_16x16x32_bf16 v[64:67], v[120:123], v[200:203], v[64:67]
    buffer_load_dwordx4 v[232:235], v4, s[12:15], s81 offen sc1
    s_add_u32 s81, s81, 132096
    s_waitcnt vmcnt(7) lgkmcnt(5)
    ds_read_b128 v[104:107], v6 offset:10240
    ds_read_b128 v[108:111], v6 offset:11264
    ds_read_b128 v[112:115], v6 offset:12288
    ds_read_b128 v[116:119], v6 offset:13312
    ds_read_b128 v[120:123], v6 offset:14336
    v_mfma_f32_16x16x32_bf16 v[48:51], v[124:127], v[204:207], v[48:51]
    v_mfma_f32_16x16x32_bf16 v[52:55], v[128:131], v[204:207], v[52:55]
    v_mfma_f32_16x16x32_bf16 v[56:59], v[132:135], v[204:207], v[56:59]
    v_mfma_f32_16x16x32_bf16 v[60:63], v[136:139], v[204:207], v[60:63]
    v_mfma_f32_16x16x32_bf16 v[64:67], v[140:143], v[204:207], v[64:67]
    buffer_load_dwordx4 v[236:239], v4, s[12:15], s81 offen sc1
    s_add_u32 s81, s81, 132096
    s_waitcnt vmcnt(7) lgkmcnt(5)
    ds_read_b128 v[124:127], v6 offset:15360
    ds_read_b128 v[128:131], v6 offset:16384
    ds_read_b128 v[132:135], v6 offset:17408
    ds_read_b128 v[136:139], v6 offset:18432
    ds_read_b128 v[140:143], v6 offset:19456
    v_mfma_f32_16x16x32_bf16 v[48:51], v[144:147], v[208:211], v[48:51]
    v_mfma_f32_16x16x32_bf16 v[52:55], v[148:151], v[208:211], v[52:55]
    v_mfma_f32_16x16x32_bf16 v[56:59], v[152:155], v[208:211], v[56:59]
    v_mfma_f32_16x16x32_bf16 v[60:63], v[156:159], v[208:211], v[60:63]
    v_mfma_f32_16x16x32_bf16 v[64:67], v[160:163], v[208:211], v[64:67]
    buffer_load_dwordx4 v[240:243], v4, s[12:15], s81 offen sc1
    s_add_u32 s81, s81, 132096
    s_waitcnt vmcnt(7) lgkmcnt(5)
    ds_read_b128 v[144:147], v6 offset:20480
    ds_read_b128 v[148:151], v6 offset:21504
    ds_read_b128 v[152:155], v6 offset:22528
    ds_read_b128 v[156:159], v6 offset:23552
    ds_read_b128 v[160:163], v6 offset:24576
    v_mfma_f32_16x16x32_bf16 v[48:51], v[104:107], v[212:215], v[48:51]
    v_mfma_f32_16x16x32_bf16 v[52:55], v[108:111], v[212:215], v[52:55]
    v_mfma_f32_16x16x32_bf16 v[56:59], v[112:115], v[212:215], v[56:59]
    v_mfma_f32_16x16x32_bf16 v[60:63], v[116:119], v[212:215], v[60:63]
    v_mfma_f32_16x16x32_bf16 v[64:67], v[120:123], v[212:215], v[64:67]
    s_waitcnt vmcnt(6) lgkmcnt(5)
    ds_read_b128 v[104:107], v6 offset:25600
    ds_read_b128 v[108:111], v6 offset:26624
    ds_read_b128 v[112:115], v6 offset:27648
    ds_read_b128 v[116:119], v6 offset:28672
    ds_read_b128 v[120:123], v6 offset:29696
    v_mfma_f32_16x16x32_bf16 v[48:51], v[124:127], v[216:219], v[48:51]
    v_mfma_f32_16x16x32_bf16 v[52:55], v[128:131], v[216:219], v[52:55]
    v_mfma_f32_16x16x32_bf16 v[56:59], v[132:135], v[216:219], v[56:59]
    v_mfma_f32_16x16x32_bf16 v[60:63], v[136:139], v[216:219], v[60:63]
    v_mfma_f32_16x16x32_bf16 v[64:67], v[140:143], v[216:219], v[64:67]
    s_waitcnt vmcnt(5) lgkmcnt(5)
    ds_read_b128 v[124:127], v6 offset:30720
    ds_read_b128 v[128:131], v6 offset:31744
    ds_read_b128 v[132:135], v6 offset:32768
    ds_read_b128 v[136:139], v6 offset:33792
    ds_read_b128 v[140:143], v6 offset:34816
    v_mfma_f32_16x16x32_bf16 v[48:51], v[144:147], v[220:223], v[48:51]
    v_mfma_f32_16x16x32_bf16 v[52:55], v[148:151], v[220:223], v[52:55]
    v_mfma_f32_16x16x32_bf16 v[56:59], v[152:155], v[220:223], v[56:59]
    v_mfma_f32_16x16x32_bf16 v[60:63], v[156:159], v[220:223], v[60:63]
    v_mfma_f32_16x16x32_bf16 v[64:67], v[160:163], v[220:223], v[64:67]
    s_waitcnt vmcnt(4) lgkmcnt(5)
    ds_read_b128 v[144:147], v6 offset:35840
    ds_read_b128 v[148:151], v6 offset:36864
    ds_read_b128 v[152:155], v6 offset:37888
    ds_read_b128 v[156:159], v6 offset:38912
    ds_read_b128 v[160:163], v6 offset:39936
    v_mfma_f32_16x16x32_bf16 v[48:51], v[104:107], v[224:227], v[48:51]
    v_mfma_f32_16x16x32_bf16 v[52:55], v[108:111], v[224:227], v[52:55]
    v_mfma_f32_16x16x32_bf16 v[56:59], v[112:115], v[224:227], v[56:59]
    v_mfma_f32_16x16x32_bf16 v[60:63], v[116:119], v[224:227], v[60:63]
    v_mfma_f32_16x16x32_bf16 v[64:67], v[120:123], v[224:227], v[64:67]
    s_waitcnt vmcnt(3) lgkmcnt(5)
    ds_read_b128 v[104:107], v6 offset:40960
    ds_read_b128 v[108:111], v6 offset:41984
    ds_read_b128 v[112:115], v6 offset:43008
    ds_read_b128 v[116:119], v6 offset:44032
    ds_read_b128 v[120:123], v6 offset:45056
    v_mfma_f32_16x16x32_bf16 v[48:51], v[124:127], v[228:231], v[48:51]
    v_mfma_f32_16x16x32_bf16 v[52:55], v[128:131], v[228:231], v[52:55]
    v_mfma_f32_16x16x32_bf16 v[56:59], v[132:135], v[228:231], v[56:59]
    v_mfma_f32_16x16x32_bf16 v[60:63], v[136:139], v[228:231], v[60:63]
    v_mfma_f32_16x16x32_bf16 v[64:67], v[140:143], v[228:231], v[64:67]
    s_waitcnt vmcnt(2) lgkmcnt(5)
    ds_read_b128 v[124:127], v6 offset:46080
    ds_read_b128 v[128:131], v6 offset:47104
    ds_read_b128 v[132:135], v6 offset:48128
    ds_read_b128 v[136:139], v6 offset:49152
    ds_read_b128 v[140:143], v6 offset:50176
    v_mfma_f32_16x16x32_bf16 v[48:51], v[144:147], v[232:235], v[48:51]
    v_mfma_f32_16x16x32_bf16 v[52:55], v[148:151], v[232:235], v[52:55]
    v_mfma_f32_16x16x32_bf16 v[56:59], v[152:155], v[232:235], v[56:59]
    v_mfma_f32_16x16x32_bf16 v[60:63], v[156:159], v[232:235], v[60:63]
    v_mfma_f32_16x16x32_bf16 v[64:67], v[160:163], v[232:235], v[64:67]
    s_waitcnt vmcnt(1) lgkmcnt(5)
    v_mfma_f32_16x16x32_bf16 v[48:51], v[104:107], v[236:239], v[48:51]
    v_mfma_f32_16x16x32_bf16 v[52:55], v[108:111], v[236:239], v[52:55]
    v_mfma_f32_16x16x32_bf16 v[56:59], v[112:115], v[236:239], v[56:59]
    v_mfma_f32_16x16x32_bf16 v[60:63], v[116:119], v[236:239], v[60:63]
    v_mfma_f32_16x16x32_bf16 v[64:67], v[120:123], v[236:239], v[64:67]
    s_waitcnt vmcnt(0) lgkmcnt(0)
    v_mfma_f32_16x16x32_bf16 v[48:51], v[124:127], v[240:243], v[48:51]
    v_mfma_f32_16x16x32_bf16 v[52:55], v[128:131], v[240:243], v[52:55]
    v_mfma_f32_16x16x32_bf16 v[56:59], v[132:135], v[240:243], v[56:59]
    v_mfma_f32_16x16x32_bf16 v[60:63], v[136:139], v[240:243], v[60:63]
    v_mfma_f32_16x16x32_bf16 v[64:67], v[140:143], v[240:243], v[64:67]
    s_barrier
    s_nop 4
    s_cmp_eq_u32 s88, 1
    s_cbranch_scc1 L_ep_w1
    s_cmp_eq_u32 s88, 2
    s_cbranch_scc1 L_ep_w2
    ds_read_b128 v[104:107], v7 offset:0
    ds_read_b128 v[108:111], v7 offset:64
    ds_read_b128 v[112:115], v7 offset:128
    ds_read_b128 v[116:119], v7 offset:192
    ds_read_b128 v[120:123], v7 offset:256
    ds_read_b128 v[124:127], v7 offset:320
    ds_read_b128 v[128:131], v7 offset:384
    ds_read_b128 v[132:135], v7 offset:448
    ds_read_b128 v[136:139], v7 offset:512
    ds_read_b128 v[140:143], v7 offset:576
    ds_read_b128 v[144:147], v7 offset:640
    ds_read_b128 v[148:151], v7 offset:704
    ds_read_b128 v[152:155], v7 offset:768
    ds_read_b128 v[156:159], v7 offset:832
    ds_read_b128 v[160:163], v7 offset:896
    s_waitcnt lgkmcnt(10)
    v_pk_fma_f32 v[8:9], v[104:105], v[48:49], v[8:9]
    v_pk_fma_f32 v[10:11], v[106:107], v[50:51], v[10:11]
    v_pk_fma_f32 v[12:13], v[108:109], v[52:53], v[12:13]
    v_pk_fma_f32 v[14:15], v[110:111], v[54:55], v[14:15]
    v_pk_fma_f32 v[16:17], v[112:113], v[56:57], v[16:17]
    v_pk_fma_f32 v[18:19], v[114:115], v[58:59], v[18:19]
    v_pk_fma_f32 v[20:21], v[116:117], v[60:61], v[20:21]
    v_pk_fma_f32 v[22:23], v[118:119], v[62:63], v[22:23]
    v_pk_fma_f32 v[24:25], v[120:121], v[64:65], v[24:25]
    v_pk_fma_f32 v[26:27], v[122:123], v[66:67], v[26:27]
    s_waitcnt lgkmcnt(5)
    v_pk_mul_f32 v[48:49], v[8:9], v[124:125]
    v_pk_mul_f32 v[50:51], v[10:11], v[126:127]
    v_pk_mul_f32 v[52:53], v[12:13], v[128:129]
    v_pk_mul_f32 v[54:55], v[14:15], v[130:131]
    v_pk_mul_f32 v[56:57], v[16:17], v[132:133]
    v_pk_mul_f32 v[58:59], v[18:19], v[134:135]
    v_pk_mul_f32 v[60:61], v[20:21], v[136:137]
    v_pk_mul_f32 v[62:63], v[22:23], v[138:139]
    v_pk_mul_f32 v[64:65], v[24:25], v[140:141]
    v_pk_mul_f32 v[66:67], v[26:27], v[142:143]
    v_cvt_pk_bf16_f32 v164, v48, v49
    v_cvt_pk_bf16_f32 v165, v50, v51
    v_cvt_pk_bf16_f32 v166, v52, v53
    v_cvt_pk_bf16_f32 v167, v54, v55
    v_cvt_pk_bf16_f32 v168, v56, v57
    v_cvt_pk_bf16_f32 v169, v58, v59
    v_cvt_pk_bf16_f32 v170, v60, v61
    v_cvt_pk_bf16_f32 v171, v62, v63
    v_cvt_pk_bf16_f32 v172, v64, v65
    v_cvt_pk_bf16_f32 v173, v66, v67
    s_add_u32 s28, s97, 16318464
    s_add_u32 s27, s28, 132096
    s_add_u32 s26, s96, 16318464
    s_cmp_eq_u32 s100, 0
    s_cbranch_scc1 L_sv_36
    buffer_store_dwordx4 v[164:167], v4, s[8:11], s28 offen
    buffer_store_dwordx4 v[168:171], v4, s[8:11], s27 offen
    buffer_store_dwordx2 v[172:173], v4, s[8:11], s26 offen
    s_branch L_sv_37
L_sv_36:
    buffer_store_dwordx4 v[164:167], v4, s[8:11], s28 offen sc1
    buffer_store_dwordx4 v[168:171], v4, s[8:11], s27 offen sc1
    buffer_store_dwordx2 v[172:173], v4, s[8:11], s26 offen sc1
L_sv_37:
    s_waitcnt lgkmcnt(0)
    v_mov_b64 v[176:177], v[8:9]
    v_pk_mul_f32 v[178:179], v[8:9], v[8:9]
    v_mov_b64 v[180:181], v[48:49]
    v_pk_mul_f32 v[182:183], v[48:49], v[48:49]
    v_pk_mul_f32 v[184:185], v[48:49], v[124:125]
    v_pk_mul_f32 v[186:187], v[48:49], v[144:145]
    v_pk_add_f32 v[176:177], v[176:177], v[10:11]
    v_pk_fma_f32 v[178:179], v[10:11], v[10:11], v[178:179]
    v_pk_add_f32 v[180:181], v[180:181], v[50:51]
    v_pk_fma_f32 v[182:183], v[50:51], v[50:51], v[182:183]
    v_pk_fma_f32 v[184:185], v[50:51], v[126:127], v[184:185]
    v_pk_fma_f32 v[186:187], v[50:51], v[146:147], v[186:187]
    v_pk_add_f32 v[176:177], v[176:177], v[12:13]
    v_pk_fma_f32 v[178:179], v[12:13], v[12:13], v[178:179]
    v_pk_add_f32 v[180:181], v[180:181], v[52:53]
    v_pk_fma_f32 v[182:183], v[52:53], v[52:53], v[182:183]
    v_pk_fma_f32 v[184:185], v[52:53], v[128:129], v[184:185]
    v_pk_fma_f32 v[186:187], v[52:53], v[148:149], v[186:187]
    v_pk_add_f32 v[176:177], v[176:177], v[14:15]
    v_pk_fma_f32 v[178:179], v[14:15], v[14:15], v[178:179]
    v_pk_add_f32 v[180:181], v[180:181], v[54:55]
    v_pk_fma_f32 v[182:183], v[54:55], v[54:55], v[182:183]
    v_pk_fma_f32 v[184:185], v[54:55], v[130:131], v[184:185]
    v_pk_fma_f32 v[186:187], v[54:55], v[150:151], v[186:187]
    v_pk_add_f32 v[176:177], v[176:177], v[16:17]
    v_pk_fma_f32 v[178:179], v[16:17], v[16:17], v[178:179]
    v_pk_add_f32 v[180:181], v[180:181], v[56:57]
    v_pk_fma_f32 v[182:183], v[56:57], v[56:57], v[182:183]
    v_pk_fma_f32 v[184:185], v[56:57], v[132:133], v[184:185]
    v_pk_fma_f32 v[186:187], v[56:57], v[152:153], v[186:187]
    v_pk_add_f32 v[176:177], v[176:177], v[18:19]
    v_pk_fma_f32 v[178:179], v[18:19], v[18:19], v[178:179]
    v_pk_add_f32 v[180:181], v[180:181], v[58:59]
    v_pk_fma_f32 v[182:183], v[58:59], v[58:59], v[182:183]
    v_pk_fma_f32 v[184:185], v[58:59], v[134:135], v[184:185]
    v_pk_fma_f32 v[186:187], v[58:59], v[154:155], v[186:187]
    v_pk_add_f32 v[176:177], v[176:177], v[20:21]
    v_pk_fma_f32 v[178:179], v[20:21], v[20:21], v[178:179]
    v_pk_add_f32 v[180:181], v[180:181], v[60:61]
    v_pk_fma_f32 v[182:183], v[60:61], v[60:61], v[182:183]
    v_pk_fma_f32 v[184:185], v[60:61], v[136:137], v[184:185]
    v_pk_fma_f32 v[186:187], v[60:61], v[156:157], v[186:187]
    v_pk_add_f32 v[176:177], v[176:177], v[22:23]
    v_pk_fma_f32 v[178:179], v[22:23], v[22:23], v[178:179]
    v_pk_add_f32 v[180:181], v[180:181], v[62:63]
    v_pk_fma_f32 v[182:183], v[62:63], v[62:63], v[182:183]
    v_pk_fma_f32 v[184:185], v[62:63], v[138:139], v[184:185]
    v_pk_fma_f32 v[186:187], v[62:63], v[158:159], v[186:187]
    v_pk_add_f32 v[176:177], v[176:177], v[24:25]
    v_pk_fma_f32 v[178:179], v[24:25], v[24:25], v[178:179]
    v_pk_add_f32 v[180:181], v[180:181], v[64:65]
    v_pk_fma_f32 v[182:183], v[64:65], v[64:65], v[182:183]
    v_pk_fma_f32 v[184:185], v[64:65], v[140:141], v[184:185]
    v_pk_fma_f32 v[186:187], v[64:65], v[160:161], v[186:187]
    v_pk_add_f32 v[176:177], v[176:177], v[26:27]
    v_pk_fma_f32 v[178:179], v[26:27], v[26:27], v[178:179]
    v_pk_add_f32 v[180:181], v[180:181], v[66:67]
    v_pk_fma_f32 v[182:183], v[66:67], v[66:67], v[182:183]
    v_pk_fma_f32 v[184:185], v[66:67], v[142:143], v[184:185]
    v_pk_fma_f32 v[186:187], v[66:67], v[162:163], v[186:187]
    v_add_f32 v244, v176, v177
    v_add_f32 v245, v178, v179
    v_add_f32 v246, v180, v181
    v_add_f32 v247, v182, v183
    v_add_f32 v248, v184, v185
    v_add_f32 v249, v186, v187
    v_mov_b32 v176, v244
    v_mov_b32 v177, v245
    v_mov_b32 v178, v246
    v_mov_b32 v179, v247
    v_mov_b32 v180, v248
    v_mov_b32 v181, v249
    v_permlane32_swap_b32 v244, v176
    v_permlane32_swap_b32 v245, v177
    v_permlane32_swap_b32 v246, v178
    v_permlane32_swap_b32 v247, v179
    v_permlane32_swap_b32 v248, v180
    v_permlane32_swap_b32 v249, v181
    v_add_f32 v244, v244, v176
    v_add_f32 v245, v245, v177
    v_add_f32 v246, v246, v178
    v_add_f32 v247, v247, v179
    v_add_f32 v248, v248, v180
    v_add_f32 v249, v249, v181
    v_mov_b32 v176, v244
    v_mov_b32 v177, v245
    v_mov_b32 v178, v246
    v_mov_b32 v179, v247
    v_mov_b32 v180, v248
    v_mov_b32 v181, v249
    v_permlane16_swap_b32 v244, v176
    v_permlane16_swap_b32 v245, v177
    v_permlane16_swap_b32 v246, v178
    v_permlane16_swap_b32 v247, v179
    v_permlane16_swap_b32 v248, v180
    v_permlane16_swap_b32 v249, v181
    v_add_f32 v244, v244, v176
    v_add_f32 v245, v245, v177
    v_add_f32 v246, v246, v178
    v_add_f32 v247, v247, v179
    v_add_f32 v248, v248, v180
    v_add_f32 v249, v249, v181
    s_lshl_b32 s28, s78, 12
    s_lshl_b32 s26, s73, 9
    s_add_u32 s28, s28, s26
    s_add_u32 s28, s28, 131072
    v_lshlrev_b32 v184, 5, v2
    s_mov_b64 exec, 0xffff
    s_cmp_eq_u32 s100, 0
    s_cbranch_scc1 L_sv_38
    buffer_store_dwordx4 v[244:247], v184, s[8:11], s28 offen
    buffer_store_dwordx2 v[248:249], v184, s[8:11], s28 offen offset:16
    s_branch L_sv_39
L_sv_38:
    buffer_store_dwordx4 v[244:247], v184, s[8:11], s28 offen sc1
    buffer_store_dwordx2 v[248:249], v184, s[8:11], s28 offen offset:16 sc1
L_sv_39:
    s_mov_b64 exec, -1
    s_mul_i32 s25, s78, 32
    s_lshl_b32 s29, s73, 2
    s_add_u32 s25, s25, s29
    s_add_u32 s25, s25, 36864
    s_waitcnt vmcnt(0)
    v_mov_b32 v186, s79
    v_mov_b32 v187, 0
    s_mov_b64 exec, 1
    s_cmp_eq_u32 s100, 0
    s_cbranch_scc1 L_sv_40
    buffer_store_dword v186, v187, s[8:11], s25 offen
    s_branch L_sv_41
L_sv_40:
    buffer_store_dword v186, v187, s[8:11], s25 offen sc1
L_sv_41:
    s_mov_b64 exec, -1
    s_barrier
    s_mul_i32 s24, s78, 32
    s_add_u32 s24, s24, 36864
    v_lshlrev_b32 v244, 2, v1
    s_mov_b64 exec, 0xff
    s_mov_b32 s101, 0x40000
L_poll_42:
    buffer_load_dword v245, v244, s[8:11], s24 offen sc1
    s_waitcnt vmcnt(0)
    v_cmp_ne_u32 vcc, s79, v245
    s_sub_u32 s101, s101, 1
    s_cmp_eq_u64 vcc, 0
    s_cbranch_scc1 L_polld_43
    s_cmp_lg_u32 s101, 0
    s_cbranch_scc1 L_poll_42
L_polld_43:
    s_mov_b64 exec, -1
    s_add_u32 s12, s68, 16318464
    s_addc_u32 s13, s69, 0
    s_mov_b32 s14, 2641920
    s_mov_b32 s15, 0x00020000
    s_mov_b32 s81, 0
    s_mov_b32 s82, 0
    s_mov_b32 s83, 0
    s_mov_b32 s84, 0
    s_mov_b32 s88, 1
    s_branch L_g_entry
L_ep_w1:
    s_lshl_b32 s24, s75, 10
    s_add_u32 s24, s24, 151808
    v_lshl_add_u32 v250, v2, 5, s24
    ds_read_b128 v[244:247], v250
    ds_read_b64 v[248:249], v250 offset:16
    ds_read_b128 v[104:107], v7 offset:1280
    ds_read_b128 v[108:111], v7 offset:1344
    ds_read_b128 v[112:115], v7 offset:1408
    ds_read_b128 v[116:119], v7 offset:1472
    ds_read_b128 v[120:123], v7 offset:1536
    ds_read_b128 v[124:127], v7 offset:1600
    ds_read_b128 v[128:131], v7 offset:1664
    ds_read_b128 v[132:135], v7 offset:1728
    ds_read_b128 v[136:139], v7 offset:1792
    ds_read_b128 v[140:143], v7 offset:1856
    ds_read_b128 v[144:147], v7 offset:1920
    ds_read_b128 v[148:151], v7 offset:1984
    ds_read_b128 v[152:155], v7 offset:2048
    ds_read_b128 v[156:159], v7 offset:2112
    ds_read_b128 v[160:163], v7 offset:2176
    s_waitcnt lgkmcnt(15)
    v_mov_b32 v180, v249
    v_mov_b32 v181, v249
    v_mov_b32 v182, v247
    v_mov_b32 v183, v247
    v_mov_b32 v184, v248
    v_mov_b32 v185, v248
    v_mov_b32 v186, v246
    v_mov_b32 v187, v246
    v_mov_b32 v188, v244
    v_mov_b32 v189, v244
    v_mov_b32 v190, v245
    v_mov_b32 v191, v245
    s_waitcnt lgkmcnt(0)
    v_pk_mul_f32 v[124:125], v[124:125], v[180:181]
    v_pk_mul_f32 v[126:127], v[126:127], v[180:181]
    v_pk_mul_f32 v[128:129], v[128:129], v[180:181]
    v_pk_mul_f32 v[130:131], v[130:131], v[180:181]
    v_pk_mul_f32 v[132:133], v[132:133], v[180:181]
    v_pk_mul_f32 v[134:135], v[134:135], v[180:181]
    v_pk_mul_f32 v[136:137], v[136:137], v[180:181]
    v_pk_mul_f32 v[138:139], v[138:139], v[180:181]
    v_pk_mul_f32 v[140:141], v[140:141], v[180:181]
    v_pk_mul_f32 v[142:143], v[142:143], v[180:181]
    v_pk_fma_f32 v[124:125], v[144:145], v[182:183], v[124:125]
    v_pk_fma_f32 v[126:127], v[146:147], v[182:183], v[126:127]
    v_pk_fma_f32 v[128:129], v[148:149], v[182:183], v[128:129]
    v_pk_fma_f32 v[130:131], v[150:151], v[182:183], v[130:131]
    v_pk_fma_f32 v[132:133], v[152:153], v[182:183], v[132:133]
    v_pk_fma_f32 v[134:135], v[154:155], v[182:183], v[134:135]
    v_pk_fma_f32 v[136:137], v[156:157], v[182:183], v[136:137]
    v_pk_fma_f32 v[138:139], v[158:159], v[182:183], v[138:139]
    v_pk_fma_f32 v[140:141], v[160:161], v[182:183], v[140:141]
    v_pk_fma_f32 v[142:143], v[162:163], v[182:183], v[142:143]
    v_pk_fma_f32 v[124:125], v[104:105], v[184:185], v[124:125]
    v_pk_fma_f32 v[126:127], v[106:107], v[184:185], v[126:127]
    v_pk_fma_f32 v[128:129], v[108:109], v[184:185], v[128:129]
    v_pk_fma_f32 v[130:131], v[110:111], v[184:185], v[130:131]
    v_pk_fma_f32 v[132:133], v[112:113], v[184:185], v[132:133]
    v_pk_fma_f32 v[134:135], v[114:115], v[184:185], v[134:135]
    v_pk_fma_f32 v[136:137], v[116:117], v[184:185], v[136:137]
    v_pk_fma_f32 v[138:139], v[118:119], v[184:185], v[138:139]
    v_pk_fma_f32 v[140:141], v[120:121], v[184:185], v[140:141]
    v_pk_fma_f32 v[142:143], v[122:123], v[184:185], v[142:143]
    v_pk_fma_f32 v[48:49], v[48:49], v[186:187], v[124:125]
    v_pk_fma_f32 v[50:51], v[50:51], v[186:187], v[126:127]
    v_pk_fma_f32 v[52:53], v[52:53], v[186:187], v[128:129]
    v_pk_fma_f32 v[54:55], v[54:55], v[186:187], v[130:131]
    v_pk_fma_f32 v[56:57], v[56:57], v[186:187], v[132:133]
    v_pk_fma_f32 v[58:59], v[58:59], v[186:187], v[134:135]
    v_pk_fma_f32 v[60:61], v[60:61], v[186:187], v[136:137]
    v_pk_fma_f32 v[62:63], v[62:63], v[186:187], v[138:139]
    v_pk_fma_f32 v[64:65], v[64:65], v[186:187], v[140:141]
    v_pk_fma_f32 v[66:67], v[66:67], v[186:187], v[142:143]
    v_mov_b32 v248, 0xbdd2d3e8
    v_mov_b32 v249, v248
    v_mov_b32 v250, 0xc0135761
    v_mov_b32 v251, v250
    v_pk_mul_f32 v[104:105], v[48:49], v[48:49]
    v_pk_mul_f32 v[106:107], v[50:51], v[50:51]
    v_pk_mul_f32 v[108:109], v[52:53], v[52:53]
    v_pk_mul_f32 v[110:111], v[54:55], v[54:55]
    v_pk_mul_f32 v[112:113], v[56:57], v[56:57]
    v_pk_mul_f32 v[114:115], v[58:59], v[58:59]
    v_pk_mul_f32 v[116:117], v[60:61], v[60:61]
    v_pk_mul_f32 v[118:119], v[62:63], v[62:63]
    v_pk_mul_f32 v[120:121], v[64:65], v[64:65]
    v_pk_mul_f32 v[122:123], v[66:67], v[66:67]
    v_pk_fma_f32 v[104:105], v[104:105], v[248:249], v[250:251]
    v_pk_fma_f32 v[106:107], v[106:107], v[248:249], v[250:251]
    v_pk_fma_f32 v[108:109], v[108:109], v[248:249], v[250:251]
    v_pk_fma_f32 v[110:111], v[110:111], v[248:249], v[250:251]
    v_pk_fma_f32 v[112:113], v[112:113], v[248:249], v[250:251]
    v_pk_fma_f32 v[114:115], v[114:115], v[248:249], v[250:251]
    v_pk_fma_f32 v[116:117], v[116:117], v[248:249], v[250:251]
    v_pk_fma_f32 v[118:119], v[118:119], v[248:249], v[250:251]
    v_pk_fma_f32 v[120:121], v[120:121], v[248:249], v[250:251]
    v_pk_fma_f32 v[122:123], v[122:123], v[248:249], v[250:251]
    v_pk_mul_f32 v[104:105], v[104:105], v[48:49]
    v_pk_mul_f32 v[106:107], v[106:107], v[50:51]
    v_pk_mul_f32 v[108:109], v[108:109], v[52:53]
    v_pk_mul_f32 v[110:111], v[110:111], v[54:55]
    v_pk_mul_f32 v[112:113], v[112:113], v[56:57]
    v_pk_mul_f32 v[114:115], v[114:115], v[58:59]
    v_pk_mul_f32 v[116:117], v[116:117], v[60:61]
    v_pk_mul_f32 v[118:119], v[118:119], v[62:63]
    v_pk_mul_f32 v[120:121], v[120:121], v[64:65]
    v_pk_mul_f32 v[122:123], v[122:123], v[66:67]
    v_exp_f32 v104, v104
    v_exp_f32 v105, v105
    v_exp_f32 v106, v106
    v_exp_f32 v107, v107
    v_exp_f32 v108, v108
    v_exp_f32 v109, v109
    v_exp_f32 v110, v110
    v_exp_f32 v111, v111
    v_exp_f32 v112, v112
    v_exp_f32 v113, v113
    v_exp_f32 v114, v114
    v_exp_f32 v115, v115
    v_exp_f32 v116, v116
    v_exp_f32 v117, v117
    v_exp_f32 v118, v118
    v_exp_f32 v119, v119
    v_exp_f32 v120, v120
    v_exp_f32 v121, v121
    v_exp_f32 v122, v122
    v_exp_f32 v123, v123
    v_add_f32 v104, 1.0, v104
    v_add_f32 v105, 1.0, v105
    v_add_f32 v106, 1.0, v106
    v_add_f32 v107, 1.0, v107
    v_add_f32 v108, 1.0, v108
    v_add_f32 v109, 1.0, v109
    v_add_f32 v110, 1.0, v110
    v_add_f32 v111, 1.0, v111
    v_add_f32 v112, 1.0, v112
    v_add_f32 v113, 1.0, v113
    v_add_f32 v114, 1.0, v114
    v_add_f32 v115, 1.0, v115
    v_add_f32 v116, 1.0, v116
    v_add_f32 v117, 1.0, v117
    v_add_f32 v118, 1.0, v118
    v_add_f32 v119, 1.0, v119
    v_add_f32 v120, 1.0, v120
    v_add_f32 v121, 1.0, v121
    v_add_f32 v122, 1.0, v122
    v_add_f32 v123, 1.0, v123
    v_rcp_f32 v104, v104
    v_rcp_f32 v105, v105
    v_rcp_f32 v106, v106
    v_rcp_f32 v107, v107
    v_rcp_f32 v108, v108
    v_rcp_f32 v109, v109
    v_rcp_f32 v110, v110
    v_rcp_f32 v111, v111
    v_rcp_f32 v112, v112
    v_rcp_f32 v113, v113
    v_rcp_f32 v114, v114
    v_rcp_f32 v115, v115
    v_rcp_f32 v116, v116
    v_rcp_f32 v117, v117
    v_rcp_f32 v118, v118
    v_rcp_f32 v119, v119
    v_rcp_f32 v120, v120
    v_rcp_f32 v121, v121
    v_rcp_f32 v122, v122
    v_rcp_f32 v123, v123
    s_nop 0
    v_pk_mul_f32 v[48:49], v[48:49], v[104:105]
    v_pk_mul_f32 v[50:51], v[50:51], v[106:107]
    v_pk_mul_f32 v[52:53], v[52:53], v[108:109]
    v_pk_mul_f32 v[54:55], v[54:55], v[110:111]
    v_pk_mul_f32 v[56:57], v[56:57], v[112:113]
    v_pk_mul_f32 v[58:59], v[58:59], v[114:115]
    v_pk_mul_f32 v[60:61], v[60:61], v[116:117]
    v_pk_mul_f32 v[62:63], v[62:63], v[118:119]
    v_pk_mul_f32 v[64:65], v[64:65], v[120:121]
    v_pk_mul_f32 v[66:67], v[66:67], v[122:123]
    v_cvt_pk_bf16_f32 v164, v48, v49
    v_cvt_pk_bf16_f32 v165, v50, v51
    v_cvt_pk_bf16_f32 v166, v52, v53
    v_cvt_pk_bf16_f32 v167, v54, v55
    v_cvt_pk_bf16_f32 v168, v56, v57
    v_cvt_pk_bf16_f32 v169, v58, v59
    v_cvt_pk_bf16_f32 v170, v60, v61
    v_cvt_pk_bf16_f32 v171, v62, v63
    v_cvt_pk_bf16_f32 v172, v64, v65
    v_cvt_pk_bf16_f32 v173, v66, v67
    s_add_u32 s28, s97, 13631488
    s_add_u32 s27, s28, 132096
    s_add_u32 s26, s96, 13631488
    s_and_b32 s90, s78, 15
    s_cmp_eq_u32 s90, 0
    s_cbranch_scc1 L_e_top
    s_cmp_eq_u32 s90, 15
    s_cbranch_scc0 L_e_nohalo
    s_mov_b32 exec_lo, 0xc000c000
    s_mov_b32 exec_hi, 0xc000c000
    s_branch L_e_st
L_e_top:
    s_mov_b32 exec_lo, 0x00030003
    s_mov_b32 exec_hi, 0x00030003
L_e_st:
    buffer_store_dwordx4 v[164:167], v4, s[8:11], s28 offen sc1
    buffer_store_dwordx4 v[168:171], v4, s[8:11], s27 offen sc1
    buffer_store_dwordx2 v[172:173], v4, s[8:11], s26 offen sc1
    s_not_b64 exec, exec
L_e_nohalo:
    s_cmp_eq_u32 s100, 0
    s_cbranch_scc1 L_sv_44
    buffer_store_dwordx4 v[164:167], v4, s[8:11], s28 offen
    buffer_store_dwordx4 v[168:171], v4, s[8:11], s27 offen
    buffer_store_dwordx2 v[172:173], v4, s[8:11], s26 offen
    s_branch L_sv_45
L_sv_44:
    buffer_store_dwordx4 v[164:167], v4, s[8:11], s28 offen sc1
    buffer_store_dwordx4 v[168:171], v4, s[8:11], s27 offen sc1
    buffer_store_dwordx2 v[172:173], v4, s[8:11], s26 offen sc1
L_sv_45:
    s_mov_b64 exec, -1
    s_mul_i32 s25, s78, 32
    s_lshl_b32 s29, s73, 2
    s_add_u32 s25, s25, s29
    s_add_u32 s25, s25, 45056
    ds_read_b128 v[104:107], v7 offset:320
    ds_read_b128 v[108:111], v7 offset:384
    ds_read_b128 v[112:115], v7 offset:448
    ds_read_b128 v[116:119], v7 offset:512
    ds_read_b128 v[120:123], v7 offset:576
    ds_read_b128 v[124:127], v7 offset:640
    ds_read_b128 v[128:131], v7 offset:704
    ds_read_b128 v[132:135], v7 offset:768
    ds_read_b128 v[136:139], v7 offset:832
    ds_read_b128 v[140:143], v7 offset:896
    s_waitcnt lgkmcnt(0)
    v_pk_add_f32 v[28:29], v[8:9], v[188:189] neg_lo:[0,1] neg_hi:[0,1]
    v_pk_add_f32 v[30:31], v[10:11], v[188:189] neg_lo:[0,1] neg_hi:[0,1]
    v_pk_add_f32 v[32:33], v[12:13], v[188:189] neg_lo:[0,1] neg_hi:[0,1]
    v_pk_add_f32 v[34:35], v[14:15], v[188:189] neg_lo:[0,1] neg_hi:[0,1]
    v_pk_add_f32 v[36:37], v[16:17], v[188:189] neg_lo:[0,1] neg_hi:[0,1]
    v_pk_add_f32 v[38:39], v[18:19], v[188:189] neg_lo:[0,1] neg_hi:[0,1]
    v_pk_add_f32 v[40:41], v[20:21], v[188:189] neg_lo:[0,1] neg_hi:[0,1]
    v_pk_add_f32 v[42:43], v[22:23], v[188:189] neg_lo:[0,1] neg_hi:[0,1]
    v_pk_add_f32 v[44:45], v[24:25], v[188:189] neg_lo:[0,1] neg_hi:[0,1]
    v_pk_add_f32 v[46:47], v[26:27], v[188:189] neg_lo:[0,1] neg_hi:[0,1]
    v_pk_mul_f32 v[104:105], v[104:105], v[190:191]
    v_pk_mul_f32 v[106:107], v[106:107], v[190:191]
    v_pk_mul_f32 v[108:109], v[108:109], v[190:191]
    v_pk_mul_f32 v[110:111], v[110:111], v[190:191]
    v_pk_mul_f32 v[112:113], v[112:113], v[190:191]
    v_pk_mul_f32 v[114:115], v[114:115], v[190:191]
    v_pk_mul_f32 v[116:117], v[116:117], v[190:191]
    v_pk_mul_f32 v[118:119], v[118:119], v[190:191]
    v_pk_mul_f32 v[120:121], v[120:121], v[190:191]
    v_pk_mul_f32 v[122:123], v[122:123], v[190:191]
    v_pk_fma_f32 v[28:29], v[28:29], v[104:105], v[124:125]
    v_pk_fma_f32 v[30:31], v[30:31], v[106:107], v[126:127]
    v_pk_fma_f32 v[32:33], v[32:33], v[108:109], v[128:129]
    v_pk_fma_f32 v[34:35], v[34:35], v[110:111], v[130:131]
    v_pk_fma_f32 v[36:37], v[36:37], v[112:113], v[132:133]
    v_pk_fma_f32 v[38:39], v[38:39], v[114:115], v[134:135]
    v_pk_fma_f32 v[40:41], v[40:41], v[116:117], v[136:137]
    v_pk_fma_f32 v[42:43], v[42:43], v[118:119], v[138:139]
    v_pk_fma_f32 v[44:45], v[44:45], v[120:121], v[140:141]
    v_pk_fma_f32 v[46:47], v[46:47], v[122:123], v[142:143]
    s_waitcnt vmcnt(0)
    v_mov_b32 v244, s79
    v_mov_b32 v245, 0
    s_mov_b64 exec, 1
    s_cmp_eq_u32 s100, 0
    s_cbranch_scc1 L_sv_46
    buffer_store_dword v244, v245, s[8:11], s25 offen
    s_branch L_sv_47
L_sv_46:
    buffer_store_dword v244, v245, s[8:11], s25 offen sc1
L_sv_47:
    s_mov_b64 exec, -1
    s_cmp_eq_u32 s90, 0
    s_cbranch_scc1 L_e_fl0
    s_cmp_eq_u32 s90, 15
    s_cbranch_scc0 L_e_midb
    s_mov_b32 s29, 1
    s_branch L_e_fl
L_e_fl0:
    s_mov_b32 s29, 0
L_e_fl:
    s_lshl_b32 s24, s70, 1
    s_add_u32 s24, s24, s29
    s_lshl_b32 s24, s24, 3
    s_add_u32 s24, s24, s73
    s_lshl_b32 s24, s24, 7
    s_add_u32 s24, s24, 31834112
    v_mov_b32 v244, s79
    v_mov_b32 v245, 0
    s_mov_b64 exec, 1
    buffer_store_dword v244, v245, s[8:11], s24 offen sc1
    s_mov_b64 exec, -1
    s_barrier
    s_branch L_e_poll
L_e_midb:
    s_barrier
    s_branch L_e_mid
L_e_poll:
    s_mul_i32 s24, s78, 32
    s_add_u32 s24, s24, 45056
    s_cmp_eq_u32 s90, 15
    s_cbranch_scc0 L_e_p1
    s_sub_u32 s24, s24, 32
L_e_p1:
    v_lshlrev_b32 v244, 2, v1
    s_mov_b64 exec, 0xffff
    s_mov_b32 s101, 0x40000
L_poll_48:
    buffer_load_dword v245, v244, s[8:11], s24 offen sc1
    s_waitcnt vmcnt(0)
    v_cmp_ne_u32 vcc, s79, v245
    s_sub_u32 s101, s101, 1
    s_cmp_eq_u64 vcc, 0
    s_cbranch_scc1 L_polld_49
    s_cmp_lg_u32 s101, 0
    s_cbranch_scc1 L_poll_48
L_polld_49:
    s_mov_b64 exec, -1
    s_cmp_eq_u32 s78, 0
    s_cbranch_scc1 L_w1_go
    s_cmp_eq_u32 s78, 127
    s_cbranch_scc1 L_w1_go
    s_lshl_b32 s24, s70, 1
    s_sub_u32 s25, s24, 1
    s_add_u32 s24, s24, 2
    s_cmp_eq_u32 s90, 0
    s_cselect_b32 s24, s25, s24
    s_lshl_b32 s24, s24, 10
    s_add_u32 s24, s24, 31834112
    v_lshlrev_b32 v244, 7, v1
    s_mov_b64 exec, 0xff
    s_mov_b32 s101, 0x40000
L_poll_50:
    buffer_load_dword v245, v244, s[8:11], s24 offen sc1
    s_waitcnt vmcnt(0)
    v_cmp_ne_u32 vcc, s79, v245
    s_sub_u32 s101, s101, 1
    s_cmp_eq_u64 vcc, 0
    s_cbranch_scc1 L_polld_51
    s_cmp_lg_u32 s101, 0
    s_cbranch_scc1 L_poll_50
L_polld_51:
    s_mov_b64 exec, -1
    s_branch L_w1_go
L_e_mid:
    s_mul_i32 s24, s78, 32
    s_add_u32 s24, s24, 45024
    v_lshlrev_b32 v244, 2, v1
    s_mov_b64 exec, 0xffffff
    s_mov_b32 s101, 0x40000
L_poll_52:
    buffer_load_dword v245, v244, s[8:11], s24 offen sc1
    s_waitcnt vmcnt(0)
    v_cmp_ne_u32 vcc, s79, v245
    s_sub_u32 s101, s101, 1
    s_cmp_eq_u64 vcc, 0
    s_cbranch_scc1 L_polld_53
    s_cmp_lg_u32 s101, 0
    s_cbranch_scc1 L_poll_52
L_polld_53:
    s_mov_b64 exec, -1
L_w1_go:
    s_add_u32 s12, s68, 13631456
    s_addc_u32 s13, s69, 0
    s_mov_b32 s14, 2641920
    s_mov_b32 s15, 0x00020000
    s_mov_b32 s81, 16
    s_mov_b32 s82, 32
    s_mov_b32 s83, 4294967248
    s_mov_b32 s84, 64
    s_mov_b32 s88, 2
    s_branch L_g_entry
L_ep_w2:
    v_pk_add_f32 v[28:29], v[28:29], v[48:49]
    v_pk_add_f32 v[30:31], v[30:31], v[50:51]
    v_pk_add_f32 v[32:33], v[32:33], v[52:53]
    v_pk_add_f32 v[34:35], v[34:35], v[54:55]
    v_pk_add_f32 v[36:37], v[36:37], v[56:57]
    v_pk_add_f32 v[38:39], v[38:39], v[58:59]
    v_pk_add_f32 v[40:41], v[40:41], v[60:61]
    v_pk_add_f32 v[42:43], v[42:43], v[62:63]
    v_pk_add_f32 v[44:45], v[44:45], v[64:65]
    v_pk_add_f32 v[46:47], v[46:47], v[66:67]
    v_cvt_pk_bf16_f32 v164, v28, v29
    v_cvt_pk_bf16_f32 v165, v30, v31
    v_cvt_pk_bf16_f32 v166, v32, v33
    v_cvt_pk_bf16_f32 v167, v34, v35
    v_cvt_pk_bf16_f32 v168, v36, v37
    v_cvt_pk_bf16_f32 v169, v38, v39
    v_cvt_pk_bf16_f32 v170, v40, v41
    v_cvt_pk_bf16_f32 v171, v42, v43
    v_cvt_pk_bf16_f32 v172, v44, v45
    v_cvt_pk_bf16_f32 v173, v46, v47
    s_add_u32 s28, s97, 16318464
    s_add_u32 s27, s28, 132096
    s_add_u32 s26, s96, 16318464
    s_cmp_eq_u32 s100, 0
    s_cbranch_scc1 L_sv_54
    buffer_store_dwordx4 v[164:167], v4, s[8:11], s28 offen
    buffer_store_dwordx4 v[168:171], v4, s[8:11], s27 offen
    buffer_store_dwordx2 v[172:173], v4, s[8:11], s26 offen
    s_branch L_sv_55
L_sv_54:
    buffer_store_dwordx4 v[164:167], v4, s[8:11], s28 offen sc1
    buffer_store_dwordx4 v[168:171], v4, s[8:11], s27 offen sc1
    buffer_store_dwordx2 v[172:173], v4, s[8:11], s26 offen sc1
L_sv_55:
    v_mov_b64 v[176:177], v[28:29]
    v_pk_mul_f32 v[178:179], v[28:29], v[28:29]
    v_pk_add_f32 v[176:177], v[176:177], v[30:31]
    v_pk_fma_f32 v[178:179], v[30:31], v[30:31], v[178:179]
    v_pk_add_f32 v[176:177], v[176:177], v[32:33]
    v_pk_fma_f32 v[178:179], v[32:33], v[32:33], v[178:179]
    v_pk_add_f32 v[176:177], v[176:177], v[34:35]
    v_pk_fma_f32 v[178:179], v[34:35], v[34:35], v[178:179]
    v_pk_add_f32 v[176:177], v[176:177], v[36:37]
    v_pk_fma_f32 v[178:179], v[36:37], v[36:37], v[178:179]
    v_pk_add_f32 v[176:177], v[176:177], v[38:39]
    v_pk_fma_f32 v[178:179], v[38:39], v[38:39], v[178:179]
    v_pk_add_f32 v[176:177], v[176:177], v[40:41]
    v_pk_fma_f32 v[178:179], v[40:41], v[40:41], v[178:179]
    v_pk_add_f32 v[176:177], v[176:177], v[42:43]
    v_pk_fma_f32 v[178:179], v[42:43], v[42:43], v[178:179]
    v_pk_add_f32 v[176:177], v[176:177], v[44:45]
    v_pk_fma_f32 v[178:179], v[44:45], v[44:45], v[178:179]
    v_pk_add_f32 v[176:177], v[176:177], v[46:47]
    v_pk_fma_f32 v[178:179], v[46:47], v[46:47], v[178:179]
    v_add_f32 v244, v176, v177
    v_add_f32 v245, v178, v179
    v_mov_b32 v176, v244
    v_mov_b32 v177, v245
    s_nop 1
    v_permlane32_swap_b32 v244, v176
    v_permlane32_swap_b32 v245, v177
    v_add_f32 v244, v244, v176
    v_add_f32 v245, v245, v177
    v_mov_b32 v176, v244
    v_mov_b32 v177, v245
    s_nop 1
    v_permlane16_swap_b32 v244, v176
    v_permlane16_swap_b32 v245, v177
    v_add_f32 v244, v244, v176
    v_add_f32 v245, v245, v177
    s_lshl_b32 s28, s78, 10
    s_lshl_b32 s26, s73, 7
    s_add_u32 s28, s28, s26
    s_add_u32 s28, s28, 655360
    v_lshlrev_b32 v178, 3, v2
    s_mov_b64 exec, 0xffff
    s_cmp_eq_u32 s100, 0
    s_cbranch_scc1 L_sv_56
    buffer_store_dwordx2 v[244:245], v178, s[8:11], s28 offen
    s_branch L_sv_57
L_sv_56:
    buffer_store_dwordx2 v[244:245], v178, s[8:11], s28 offen sc1
L_sv_57:
    s_mov_b64 exec, -1
    s_mul_i32 s25, s78, 32
    s_lshl_b32 s29, s73, 2
    s_add_u32 s25, s25, s29
    s_add_u32 s25, s25, 49152
    s_waitcnt vmcnt(0)
    v_mov_b32 v180, s79
    v_mov_b32 v181, 0
    s_mov_b64 exec, 1
    s_cmp_eq_u32 s100, 0
    s_cbranch_scc1 L_sv_58
    buffer_store_dword v180, v181, s[8:11], s25 offen
    s_branch L_sv_59
L_sv_58:
    buffer_store_dword v180, v181, s[8:11], s25 offen sc1
L_sv_59:
    s_mov_b64 exec, -1
    s_lshl_b32 s89, s70, 4
    s_lshr_b32 s24, s71, 4
    s_lshl_b32 s24, s24, 3
    s_add_u32 s89, s89, s24
    s_lshl_b32 s24, s75, 1
    s_add_u32 s89, s89, s24
    s_and_b32 s90, s71, 15
    s_barrier
    s_mul_i32 s24, s89, 32
    s_add_u32 s24, s24, 49152
    v_lshlrev_b32 v244, 2, v1
    s_mov_b64 exec, 0xffff
    s_mov_b32 s101, 0x40000
L_poll_60:
    buffer_load_dword v245, v244, s[8:11], s24 offen sc1
    s_waitcnt vmcnt(0)
    v_cmp_ne_u32 vcc, s79, v245
    s_sub_u32 s101, s101, 1
    s_cmp_eq_u64 vcc, 0
    s_cbranch_scc1 L_polld_61
    s_cmp_lg_u32 s101, 0
    s_cbranch_scc1 L_poll_60
L_polld_61:
    s_mov_b64 exec, -1
    v_mul_u32_u24 v4, 33024, v3
    v_lshl_add_u32 v4, v2, 4, v4
    s_lshl_b32 s24, s89, 8
    s_add_u32 s24, s24, 128
    v_add_u32 v4, s24, v4
    s_add_u32 s12, s68, 16318464
    s_addc_u32 s13, s69, 0
    s_mov_b32 s14, 2641920
    s_mov_b32 s15, 0x00020000
    s_mov_b32 s81, 0
    buffer_load_dwordx4 v[164:167], v4, s[12:15], s81 offen sc1
    buffer_load_dwordx4 v[168:171], v4, s[12:15], s81 offen offset:256 sc1
    s_add_u32 s81, s81, 132096
    buffer_load_dwordx4 v[172:175], v4, s[12:15], s81 offen sc1
    buffer_load_dwordx4 v[176:179], v4, s[12:15], s81 offen offset:256 sc1
    s_add_u32 s81, s81, 132096
    buffer_load_dwordx4 v[180:183], v4, s[12:15], s81 offen sc1
    buffer_load_dwordx4 v[184:187], v4, s[12:15], s81 offen offset:256 sc1
    s_add_u32 s81, s81, 132096
    buffer_load_dwordx4 v[188:191], v4, s[12:15], s81 offen sc1
    buffer_load_dwordx4 v[192:195], v4, s[12:15], s81 offen offset:256 sc1
    s_add_u32 s81, s81, 132096
    buffer_load_dwordx4 v[196:199], v4, s[12:15], s81 offen sc1
    buffer_load_dwordx4 v[200:203], v4, s[12:15], s81 offen offset:256 sc1
    s_add_u32 s81, s81, 132096
    v_mov_b64 v[48:49], 0
    v_mov_b64 v[50:51], 0
    v_mov_b64 v[52:53], 0
    v_mov_b64 v[54:55], 0
    v_mov_b64 v[56:57], 0
    v_mov_b64 v[58:59], 0
    v_mov_b64 v[60:61], 0
    v_mov_b64 v[62:63], 0
    v_mov_b64 v[64:65], 0
    v_mov_b64 v[66:67], 0
    v_mov_b64 v[68:69], 0
    v_mov_b64 v[70:71], 0
    v_mov_b64 v[72:73], 0
    v_mov_b64 v[74:75], 0
    v_mov_b64 v[76:77], 0
    v_mov_b64 v[78:79], 0
    v_mov_b64 v[80:81], 0
    v_mov_b64 v[82:83], 0
    v_mov_b64 v[84:85], 0
    v_mov_b64 v[86:87], 0
    v_mov_b64 v[88:89], 0
    v_mov_b64 v[90:91], 0
    v_mov_b64 v[92:93], 0
    v_mov_b64 v[94:95], 0
    v_mov_b64 v[96:97], 0
    v_mov_b64 v[98:99], 0
    v_mov_b64 v[100:101], 0
    v_mov_b64 v[102:103], 0
    v_lshlrev_b32 v5, 4, v1
    v_add_u32 v6, 35840, v5
    ds_read_b128 v[104:107], v5 offset:0
    ds_read_b128 v[108:111], v5 offset:1024
    ds_read_b128 v[112:115], v5 offset:2048
    ds_read_b128 v[116:119], v5 offset:3072
    ds_read_b128 v[120:123], v5 offset:4096
    ds_read_b128 v[124:127], v5 offset:5120
    ds_read_b128 v[128:131], v5 offset:6144
    s_mov_b32 s86, 0
L_w3_loop:
    s_waitcnt vmcnt(8) lgkmcnt(0)
    ds_read_b128 v[132:135], v5 offset:7168
    ds_read_b128 v[136:139], v5 offset:8192
    ds_read_b128 v[140:143], v5 offset:9216
    ds_read_b128 v[144:147], v5 offset:10240
    ds_read_b128 v[148:151], v5 offset:11264
    ds_read_b128 v[152:155], v5 offset:12288
    ds_read_b128 v[156:159], v5 offset:13312
    v_mfma_f32_16x16x32_bf16 v[48:51], v[104:107], v[164:167], v[48:51]
    v_mfma_f32_16x16x32_bf16 v[76:79], v[104:107], v[168:171], v[76:79]
    v_mfma_f32_16x16x32_bf16 v[52:55], v[108:111], v[164:167], v[52:55]
    v_mfma_f32_16x16x32_bf16 v[80:83], v[108:111], v[168:171], v[80:83]
    buffer_load_dwordx4 v[204:207], v4, s[12:15], s81 offen sc1
    buffer_load_dwordx4 v[208:211], v4, s[12:15], s81 offen offset:256 sc1
    s_add_u32 s81, s81, 132096
    v_mfma_f32_16x16x32_bf16 v[56:59], v[112:115], v[164:167], v[56:59]
    v_mfma_f32_16x16x32_bf16 v[84:87], v[112:115], v[168:171], v[84:87]
    v_mfma_f32_16x16x32_bf16 v[60:63], v[116:119], v[164:167], v[60:63]
    v_mfma_f32_16x16x32_bf16 v[88:91], v[116:119], v[168:171], v[88:91]
    v_mfma_f32_16x16x32_bf16 v[64:67], v[120:123], v[164:167], v[64:67]
    v_mfma_f32_16x16x32_bf16 v[92:95], v[120:123], v[168:171], v[92:95]
    v_mfma_f32_16x16x32_bf16 v[68:71], v[124:127], v[164:167], v[68:71]
    v_mfma_f32_16x16x32_bf16 v[96:99], v[124:127], v[168:171], v[96:99]
    v_mfma_f32_16x16x32_bf16 v[72:75], v[128:131], v[164:167], v[72:75]
    v_mfma_f32_16x16x32_bf16 v[100:103], v[128:131], v[168:171], v[100:103]
    s_waitcnt vmcnt(8) lgkmcnt(0)
    ds_read_b128 v[104:107], v5 offset:14336
    ds_read_b128 v[108:111], v5 offset:15360
    ds_read_b128 v[112:115], v5 offset:16384
    ds_read_b128 v[116:119], v5 offset:17408
    ds_read_b128 v[120:123], v5 offset:18432
    ds_read_b128 v[124:127], v5 offset:19456
    ds_read_b128 v[128:131], v5 offset:20480
    v_mfma_f32_16x16x32_bf16 v[48:51], v[132:135], v[172:175], v[48:51]
    v_mfma_f32_16x16x32_bf16 v[76:79], v[132:135], v[176:179], v[76:79]
    v_mfma_f32_16x16x32_bf16 v[52:55], v[136:139], v[172:175], v[52:55]
    v_mfma_f32_16x16x32_bf16 v[80:83], v[136:139], v[176:179], v[80:83]
    buffer_load_dwordx4 v[212:215], v4, s[12:15], s81 offen sc1
    buffer_load_dwordx4 v[216:219], v4, s[12:15], s81 offen offset:256 sc1
    s_add_u32 s81, s81, 132096
    v_mfma_f32_16x16x32_bf16 v[56:59], v[140:143], v[172:175], v[56:59]
    v_mfma_f32_16x16x32_bf16 v[84:87], v[140:143], v[176:179], v[84:87]
    v_mfma_f32_16x16x32_bf16 v[60:63], v[144:147], v[172:175], v[60:63]
    v_mfma_f32_16x16x32_bf16 v[88:91], v[144:147], v[176:179], v[88:91]
    v_mfma_f32_16x16x32_bf16 v[64:67], v[148:151], v[172:175], v[64:67]
    v_mfma_f32_16x16x32_bf16 v[92:95], v[148:151], v[176:179], v[92:95]
    v_mfma_f32_16x16x32_bf16 v[68:71], v[152:155], v[172:175], v[68:71]
    v_mfma_f32_16x16x32_bf16 v[96:99], v[152:155], v[176:179], v[96:99]
    v_mfma_f32_16x16x32_bf16 v[72:75], v[156:159], v[172:175], v[72:75]
    v_mfma_f32_16x16x32_bf16 v[100:103], v[156:159], v[176:179], v[100:103]
    s_waitcnt vmcnt(8) lgkmcnt(0)
    ds_read_b128 v[132:135], v5 offset:21504
    ds_read_b128 v[136:139], v5 offset:22528
    ds_read_b128 v[140:143], v5 offset:23552
    ds_read_b128 v[144:147], v5 offset:24576
    ds_read_b128 v[148:151], v5 offset:25600
    ds_read_b128 v[152:155], v5 offset:26624
    ds_read_b128 v[156:159], v5 offset:27648
    v_mfma_f32_16x16x32_bf16 v[48:51], v[104:107], v[180:183], v[48:51]
    v_mfma_f32_16x16x32_bf16 v[76:79], v[104:107], v[184:187], v[76:79]
    v_mfma_f32_16x16x32_bf16 v[52:55], v[108:111], v[180:183], v[52:55]
    v_mfma_f32_16x16x32_bf16 v[80:83], v[108:111], v[184:187], v[80:83]
    buffer_load_dwordx4 v[220:223], v4, s[12:15], s81 offen sc1
    buffer_load_dwordx4 v[224:227], v4, s[12:15], s81 offen offset:256 sc1
    s_add_u32 s81, s81, 132096
    v_mfma_f32_16x16x32_bf16 v[56:59], v[112:115], v[180:183], v[56:59]
    v_mfma_f32_16x16x32_bf16 v[84:87], v[112:115], v[184:187], v[84:87]
    v_mfma_f32_16x16x32_bf16 v[60:63], v[116:119], v[180:183], v[60:63]
    v_mfma_f32_16x16x32_bf16 v[88:91], v[116:119], v[184:187], v[88:91]
    v_mfma_f32_16x16x32_bf16 v[64:67], v[120:123], v[180:183], v[64:67]
    v_mfma_f32_16x16x32_bf16 v[92:95], v[120:123], v[184:187], v[92:95]
    v_mfma_f32_16x16x32_bf16 v[68:71], v[124:127], v[180:183], v[68:71]
    v_mfma_f32_16x16x32_bf16 v[96:99], v[124:127], v[184:187], v[96:99]
    v_mfma_f32_16x16x32_bf16 v[72:75], v[128:131], v[180:183], v[72:75]
    v_mfma_f32_16x16x32_bf16 v[100:103], v[128:131], v[184:187], v[100:103]
    s_waitcnt vmcnt(8) lgkmcnt(0)
    ds_read_b128 v[104:107], v5 offset:28672
    ds_read_b128 v[108:111], v5 offset:29696
    ds_read_b128 v[112:115], v5 offset:30720
    ds_read_b128 v[116:119], v5 offset:31744
    ds_read_b128 v[120:123], v5 offset:32768
    ds_read_b128 v[124:127], v5 offset:33792
    ds_read_b128 v[128:131], v5 offset:34816
    v_mfma_f32_16x16x32_bf16 v[48:51], v[132:135], v[188:191], v[48:51]
    v_mfma_f32_16x16x32_bf16 v[76:79], v[132:135], v[192:195], v[76:79]
    v_mfma_f32_16x16x32_bf16 v[52:55], v[136:139], v[188:191], v[52:55]
    v_mfma_f32_16x16x32_bf16 v[80:83], v[136:139], v[192:195], v[80:83]
    buffer_load_dwordx4 v[228:231], v4, s[12:15], s81 offen sc1
    buffer_load_dwordx4 v[232:235], v4, s[12:15], s81 offen offset:256 sc1
    s_add_u32 s81, s81, 132096
    v_mfma_f32_16x16x32_bf16 v[56:59], v[140:143], v[188:191], v[56:59]
    v_mfma_f32_16x16x32_bf16 v[84:87], v[140:143], v[192:195], v[84:87]
    v_mfma_f32_16x16x32_bf16 v[60:63], v[144:147], v[188:191], v[60:63]
    v_mfma_f32_16x16x32_bf16 v[88:91], v[144:147], v[192:195], v[88:91]
    v_mfma_f32_16x16x32_bf16 v[64:67], v[148:151], v[188:191], v[64:67]
    v_mfma_f32_16x16x32_bf16 v[92:95], v[148:151], v[192:195], v[92:95]
    v_mfma_f32_16x16x32_bf16 v[68:71], v[152:155], v[188:191], v[68:71]
    v_mfma_f32_16x16x32_bf16 v[96:99], v[152:155], v[192:195], v[96:99]
    v_mfma_f32_16x16x32_bf16 v[72:75], v[156:159], v[188:191], v[72:75]
    v_mfma_f32_16x16x32_bf16 v[100:103], v[156:159], v[192:195], v[100:103]
    s_waitcnt vmcnt(8) lgkmcnt(0)
    ds_read_b128 v[132:135], v6 offset:0
    ds_read_b128 v[136:139], v6 offset:1024
    ds_read_b128 v[140:143], v6 offset:2048
    ds_read_b128 v[144:147], v6 offset:3072
    ds_read_b128 v[148:151], v6 offset:4096
    ds_read_b128 v[152:155], v6 offset:5120
    ds_read_b128 v[156:159], v6 offset:6144
    v_mfma_f32_16x16x32_bf16 v[48:51], v[104:107], v[196:199], v[48:51]
    v_mfma_f32_16x16x32_bf16 v[76:79], v[104:107], v[200:203], v[76:79]
    v_mfma_f32_16x16x32_bf16 v[52:55], v[108:111], v[196:199], v[52:55]
    v_mfma_f32_16x16x32_bf16 v[80:83], v[108:111], v[200:203], v[80:83]
    buffer_load_dwordx4 v[236:239], v4, s[12:15], s81 offen sc1
    buffer_load_dwordx4 v[240:243], v4, s[12:15], s81 offen offset:256 sc1
    s_add_u32 s81, s81, 132096
    v_mfma_f32_16x16x32_bf16 v[56:59], v[112:115], v[196:199], v[56:59]
    v_mfma_f32_16x16x32_bf16 v[84:87], v[112:115], v[200:203], v[84:87]
    v_mfma_f32_16x16x32_bf16 v[60:63], v[116:119], v[196:199], v[60:63]
    v_mfma_f32_16x16x32_bf16 v[88:91], v[116:119], v[200:203], v[88:91]
    v_mfma_f32_16x16x32_bf16 v[64:67], v[120:123], v[196:199], v[64:67]
    v_mfma_f32_16x16x32_bf16 v[92:95], v[120:123], v[200:203], v[92:95]
    v_mfma_f32_16x16x32_bf16 v[68:71], v[124:127], v[196:199], v[68:71]
    v_mfma_f32_16x16x32_bf16 v[96:99], v[124:127], v[200:203], v[96:99]
    v_mfma_f32_16x16x32_bf16 v[72:75], v[128:131], v[196:199], v[72:75]
    v_mfma_f32_16x16x32_bf16 v[100:103], v[128:131], v[200:203], v[100:103]
    s_waitcnt vmcnt(8) lgkmcnt(0)
    ds_read_b128 v[104:107], v6 offset:7168
    ds_read_b128 v[108:111], v6 offset:8192
    ds_read_b128 v[112:115], v6 offset:9216
    ds_read_b128 v[116:119], v6 offset:10240
    ds_read_b128 v[120:123], v6 offset:11264
    ds_read_b128 v[124:127], v6 offset:12288
    ds_read_b128 v[128:131], v6 offset:13312
    v_mfma_f32_16x16x32_bf16 v[48:51], v[132:135], v[204:207], v[48:51]
    v_mfma_f32_16x16x32_bf16 v[76:79], v[132:135], v[208:211], v[76:79]
    v_mfma_f32_16x16x32_bf16 v[52:55], v[136:139], v[204:207], v[52:55]
    v_mfma_f32_16x16x32_bf16 v[80:83], v[136:139], v[208:211], v[80:83]
    buffer_load_dwordx4 v[164:167], v4, s[12:15], s81 offen sc1
    buffer_load_dwordx4 v[168:171], v4, s[12:15], s81 offen offset:256 sc1
    s_add_u32 s81, s81, 132096
    v_mfma_f32_16x16x32_bf16 v[56:59], v[140:143], v[204:207], v[56:59]
    v_mfma_f32_16x16x32_bf16 v[84:87], v[140:143], v[208:211], v[84:87]
    v_mfma_f32_16x16x32_bf16 v[60:63], v[144:147], v[204:207], v[60:63]
    v_mfma_f32_16x16x32_bf16 v[88:91], v[144:147], v[208:211], v[88:91]
    v_mfma_f32_16x16x32_bf16 v[64:67], v[148:151], v[204:207], v[64:67]
    v_mfma_f32_16x16x32_bf16 v[92:95], v[148:151], v[208:211], v[92:95]
    v_mfma_f32_16x16x32_bf16 v[68:71], v[152:155], v[204:207], v[68:71]
    v_mfma_f32_16x16x32_bf16 v[96:99], v[152:155], v[208:211], v[96:99]
    v_mfma_f32_16x16x32_bf16 v[72:75], v[156:159], v[204:207], v[72:75]
    v_mfma_f32_16x16x32_bf16 v[100:103], v[156:159], v[208:211], v[100:103]
    s_waitcnt vmcnt(8) lgkmcnt(0)
    ds_read_b128 v[132:135], v6 offset:14336
    ds_read_b128 v[136:139], v6 offset:15360
    ds_read_b128 v[140:143], v6 offset:16384
    ds_read_b128 v[144:147], v6 offset:17408
    ds_read_b128 v[148:151], v6 offset:18432
    ds_read_b128 v[152:155], v6 offset:19456
    ds_read_b128 v[156:159], v6 offset:20480
    v_mfma_f32_16x16x32_bf16 v[48:51], v[104:107], v[212:215], v[48:51]
    v_mfma_f32_16x16x32_bf16 v[76:79], v[104:107], v[216:219], v[76:79]
    v_mfma_f32_16x16x32_bf16 v[52:55], v[108:111], v[212:215], v[52:55]
    v_mfma_f32_16x16x32_bf16 v[80:83], v[108:111], v[216:219], v[80:83]
    buffer_load_dwordx4 v[172:175], v4, s[12:15], s81 offen sc1
    buffer_load_dwordx4 v[176:179], v4, s[12:15], s81 offen offset:256 sc1
    s_add_u32 s81, s81, 132096
    v_mfma_f32_16x16x32_bf16 v[56:59], v[112:115], v[212:215], v[56:59]
    v_mfma_f32_16x16x32_bf16 v[84:87], v[112:115], v[216:219], v[84:87]
    v_mfma_f32_16x16x32_bf16 v[60:63], v[116:119], v[212:215], v[60:63]
    v_mfma_f32_16x16x32_bf16 v[88:91], v[116:119], v[216:219], v[88:91]
    v_mfma_f32_16x16x32_bf16 v[64:67], v[120:123], v[212:215], v[64:67]
    v_mfma_f32_16x16x32_bf16 v[92:95], v[120:123], v[216:219], v[92:95]
    v_mfma_f32_16x16x32_bf16 v[68:71], v[124:127], v[212:215], v[68:71]
    v_mfma_f32_16x16x32_bf16 v[96:99], v[124:127], v[216:219], v[96:99]
    v_mfma_f32_16x16x32_bf16 v[72:75], v[128:131], v[212:215], v[72:75]
    v_mfma_f32_16x16x32_bf16 v[100:103], v[128:131], v[216:219], v[100:103]
    s_waitcnt vmcnt(8) lgkmcnt(0)
    ds_read_b128 v[104:107], v6 offset:21504
    ds_read_b128 v[108:111], v6 offset:22528
    ds_read_b128 v[112:115], v6 offset:23552
    ds_read_b128 v[116:119], v6 offset:24576
    ds_read_b128 v[120:123], v6 offset:25600
    ds_read_b128 v[124:127], v6 offset:26624
    ds_read_b128 v[128:131], v6 offset:27648
    v_mfma_f32_16x16x32_bf16 v[48:51], v[132:135], v[220:223], v[48:51]
    v_mfma_f32_16x16x32_bf16 v[76:79], v[132:135], v[224:227], v[76:79]
    v_mfma_f32_16x16x32_bf16 v[52:55], v[136:139], v[220:223], v[52:55]
    v_mfma_f32_16x16x32_bf16 v[80:83], v[136:139], v[224:227], v[80:83]
    buffer_load_dwordx4 v[180:183], v4, s[12:15], s81 offen sc1
    buffer_load_dwordx4 v[184:187], v4, s[12:15], s81 offen offset:256 sc1
    s_add_u32 s81, s81, 132096
    v_mfma_f32_16x16x32_bf16 v[56:59], v[140:143], v[220:223], v[56:59]
    v_mfma_f32_16x16x32_bf16 v[84:87], v[140:143], v[224:227], v[84:87]
    v_mfma_f32_16x16x32_bf16 v[60:63], v[144:147], v[220:223], v[60:63]
    v_mfma_f32_16x16x32_bf16 v[88:91], v[144:147], v[224:227], v[88:91]
    v_mfma_f32_16x16x32_bf16 v[64:67], v[148:151], v[220:223], v[64:67]
    v_mfma_f32_16x16x32_bf16 v[92:95], v[148:151], v[224:227], v[92:95]
    v_mfma_f32_16x16x32_bf16 v[68:71], v[152:155], v[220:223], v[68:71]
    v_mfma_f32_16x16x32_bf16 v[96:99], v[152:155], v[224:227], v[96:99]
    v_mfma_f32_16x16x32_bf16 v[72:75], v[156:159], v[220:223], v[72:75]
    v_mfma_f32_16x16x32_bf16 v[100:103], v[156:159], v[224:227], v[100:103]
    s_waitcnt vmcnt(8) lgkmcnt(0)
    ds_read_b128 v[132:135], v6 offset:28672
    ds_read_b128 v[136:139], v6 offset:29696
    ds_read_b128 v[140:143], v6 offset:30720
    ds_read_b128 v[144:147], v6 offset:31744
    ds_read_b128 v[148:151], v6 offset:32768
    ds_read_b128 v[152:155], v6 offset:33792
    ds_read_b128 v[156:159], v6 offset:34816
    v_mfma_f32_16x16x32_bf16 v[48:51], v[104:107], v[228:231], v[48:51]
    v_mfma_f32_16x16x32_bf16 v[76:79], v[104:107], v[232:235], v[76:79]
    v_mfma_f32_16x16x32_bf16 v[52:55], v[108:111], v[228:231], v[52:55]
    v_mfma_f32_16x16x32_bf16 v[80:83], v[108:111], v[232:235], v[80:83]
    buffer_load_dwordx4 v[188:191], v4, s[12:15], s81 offen sc1
    buffer_load_dwordx4 v[192:195], v4, s[12:15], s81 offen offset:256 sc1
    s_add_u32 s81, s81, 132096
    v_mfma_f32_16x16x32_bf16 v[56:59], v[112:115], v[228:231], v[56:59]
    v_mfma_f32_16x16x32_bf16 v[84:87], v[112:115], v[232:235], v[84:87]
    v_mfma_f32_16x16x32_bf16 v[60:63], v[116:119], v[228:231], v[60:63]
    v_mfma_f32_16x16x32_bf16 v[88:91], v[116:119], v[232:235], v[88:91]
    v_mfma_f32_16x16x32_bf16 v[64:67], v[120:123], v[228:231], v[64:67]
    v_mfma_f32_16x16x32_bf16 v[92:95], v[120:123], v[232:235], v[92:95]
    v_mfma_f32_16x16x32_bf16 v[68:71], v[124:127], v[228:231], v[68:71]
    v_mfma_f32_16x16x32_bf16 v[96:99], v[124:127], v[232:235], v[96:99]
    v_mfma_f32_16x16x32_bf16 v[72:75], v[128:131], v[228:231], v[72:75]
    v_mfma_f32_16x16x32_bf16 v[100:103], v[128:131], v[232:235], v[100:103]
    s_waitcnt vmcnt(8) lgkmcnt(0)
    v_add_u32 v5, 71680, v5
    v_add_u32 v6, 71680, v6
    ds_read_b128 v[104:107], v5 offset:0
    ds_read_b128 v[108:111], v5 offset:1024
    ds_read_b128 v[112:115], v5 offset:2048
    ds_read_b128 v[116:119], v5 offset:3072
    ds_read_b128 v[120:123], v5 offset:4096
    ds_read_b128 v[124:127], v5 offset:5120
    ds_read_b128 v[128:131], v5 offset:6144
    v_mfma_f32_16x16x32_bf16 v[48:51], v[132:135], v[236:239], v[48:51]
    v_mfma_f32_16x16x32_bf16 v[76:79], v[132:135], v[240:243], v[76:79]
    v_mfma_f32_16x16x32_bf16 v[52:55], v[136:139], v[236:239], v[52:55]
    v_mfma_f32_16x16x32_bf16 v[80:83], v[136:139], v[240:243], v[80:83]
    buffer_load_dwordx4 v[196:199], v4, s[12:15], s81 offen sc1
    buffer_load_dwordx4 v[200:203], v4, s[12:15], s81 offen offset:256 sc1
    s_add_u32 s81, s81, 132096
    v_mfma_f32_16x16x32_bf16 v[56:59], v[140:143], v[236:239], v[56:59]
    v_mfma_f32_16x16x32_bf16 v[84:87], v[140:143], v[240:243], v[84:87]
    v_mfma_f32_16x16x32_bf16 v[60:63], v[144:147], v[236:239], v[60:63]
    v_mfma_f32_16x16x32_bf16 v[88:91], v[144:147], v[240:243], v[88:91]
    v_mfma_f32_16x16x32_bf16 v[64:67], v[148:151], v[236:239], v[64:67]
    v_mfma_f32_16x16x32_bf16 v[92:95], v[148:151], v[240:243], v[92:95]
    v_mfma_f32_16x16x32_bf16 v[68:71], v[152:155], v[236:239], v[68:71]
    v_mfma_f32_16x16x32_bf16 v[96:99], v[152:155], v[240:243], v[96:99]
    v_mfma_f32_16x16x32_bf16 v[72:75], v[156:159], v[236:239], v[72:75]
    v_mfma_f32_16x16x32_bf16 v[100:103], v[156:159], v[240:243], v[100:103]
    s_add_u32 s86, s86, 1
    s_cmp_lt_u32 s86, 2
    s_cbranch_scc1 L_w3_loop
    s_waitcnt vmcnt(0) lgkmcnt(0)
    s_barrier
    s_lshl_b32 s24, s75, 10
    s_add_u32 s24, s24, 151808
    v_lshl_add_u32 v250, v2, 5, s24
    ds_read_b64 v[244:245], v250
    ds_read_b64 v[246:247], v250 offset:512
    ds_read_b128 v[132:135], v7 offset:2240
    ds_read_b128 v[136:139], v7 offset:2304
    ds_read_b128 v[140:143], v7 offset:2368
    ds_read_b128 v[144:147], v7 offset:2432
    ds_read_b128 v[148:151], v7 offset:2496
    ds_read_b128 v[152:155], v7 offset:2560
    ds_read_b128 v[156:159], v7 offset:2624
    s_waitcnt lgkmcnt(7)
    v_sub_f32 v180, 0, v244
    v_mov_b32 v182, v245
    v_mov_b32 v181, v180
    v_mov_b32 v183, v182
    v_sub_f32 v184, 0, v246
    v_mov_b32 v186, v247
    v_mov_b32 v185, v184
    v_mov_b32 v187, v186
    v_mov_b32 v248, 0xbdd2d3e8
    v_mov_b32 v249, v248
    v_mov_b32 v250, 0xc0135761
    v_mov_b32 v251, v250
    s_waitcnt lgkmcnt(0)
    s_mul_i32 s26, s90, 396288
    s_add_u32 s26, s26, 24379392
    s_add_u32 s27, s26, 132096
    s_add_u32 s28, s26, 264192
    s_lshr_b32 s24, s90, 1
    s_add_u32 s24, s24, 48
    s_mul_i32 s24, s24, 132096
    s_and_b32 s29, s90, 1
    s_lshl_b32 s29, s29, 3
    s_add_u32 s24, s24, s29
    s_add_u32 s24, s24, 24379392
    v_pk_fma_f32 v[48:49], v[132:133], v[180:181], v[48:49]
    v_pk_fma_f32 v[50:51], v[134:135], v[180:181], v[50:51]
    v_pk_fma_f32 v[52:53], v[136:137], v[180:181], v[52:53]
    v_pk_fma_f32 v[54:55], v[138:139], v[180:181], v[54:55]
    v_pk_fma_f32 v[56:57], v[140:141], v[180:181], v[56:57]
    v_pk_fma_f32 v[58:59], v[142:143], v[180:181], v[58:59]
    v_pk_fma_f32 v[60:61], v[144:145], v[180:181], v[60:61]
    v_pk_fma_f32 v[62:63], v[146:147], v[180:181], v[62:63]
    v_pk_fma_f32 v[64:65], v[148:149], v[180:181], v[64:65]
    v_pk_fma_f32 v[66:67], v[150:151], v[180:181], v[66:67]
    v_pk_fma_f32 v[68:69], v[152:153], v[180:181], v[68:69]
    v_pk_fma_f32 v[70:71], v[154:155], v[180:181], v[70:71]
    v_pk_fma_f32 v[72:73], v[156:157], v[180:181], v[72:73]
    v_pk_fma_f32 v[74:75], v[158:159], v[180:181], v[74:75]
    v_pk_mul_f32 v[48:49], v[48:49], v[182:183]
    v_pk_mul_f32 v[50:51], v[50:51], v[182:183]
    v_pk_mul_f32 v[52:53], v[52:53], v[182:183]
    v_pk_mul_f32 v[54:55], v[54:55], v[182:183]
    v_pk_mul_f32 v[56:57], v[56:57], v[182:183]
    v_pk_mul_f32 v[58:59], v[58:59], v[182:183]
    v_pk_mul_f32 v[60:61], v[60:61], v[182:183]
    v_pk_mul_f32 v[62:63], v[62:63], v[182:183]
    v_pk_mul_f32 v[64:65], v[64:65], v[182:183]
    v_pk_mul_f32 v[66:67], v[66:67], v[182:183]
    v_pk_mul_f32 v[68:69], v[68:69], v[182:183]
    v_pk_mul_f32 v[70:71], v[70:71], v[182:183]
    v_pk_mul_f32 v[72:73], v[72:73], v[182:183]
    v_pk_mul_f32 v[74:75], v[74:75], v[182:183]
    v_pk_mul_f32 v[104:105], v[48:49], v[48:49]
    v_pk_mul_f32 v[106:107], v[50:51], v[50:51]
    v_pk_mul_f32 v[108:109], v[52:53], v[52:53]
    v_pk_mul_f32 v[110:111], v[54:55], v[54:55]
    v_pk_mul_f32 v[112:113], v[56:57], v[56:57]
    v_pk_mul_f32 v[114:115], v[58:59], v[58:59]
    v_pk_mul_f32 v[116:117], v[60:61], v[60:61]
    v_pk_mul_f32 v[118:119], v[62:63], v[62:63]
    v_pk_mul_f32 v[120:121], v[64:65], v[64:65]
    v_pk_mul_f32 v[122:123], v[66:67], v[66:67]
    v_pk_mul_f32 v[124:125], v[68:69], v[68:69]
    v_pk_mul_f32 v[126:127], v[70:71], v[70:71]
    v_pk_mul_f32 v[128:129], v[72:73], v[72:73]
    v_pk_mul_f32 v[130:131], v[74:75], v[74:75]
    v_pk_fma_f32 v[104:105], v[104:105], v[248:249], v[250:251]
    v_pk_fma_f32 v[106:107], v[106:107], v[248:249], v[250:251]
    v_pk_fma_f32 v[108:109], v[108:109], v[248:249], v[250:251]
    v_pk_fma_f32 v[110:111], v[110:111], v[248:249], v[250:251]
    v_pk_fma_f32 v[112:113], v[112:113], v[248:249], v[250:251]
    v_pk_fma_f32 v[114:115], v[114:115], v[248:249], v[250:251]
    v_pk_fma_f32 v[116:117], v[116:117], v[248:249], v[250:251]
    v_pk_fma_f32 v[118:119], v[118:119], v[248:249], v[250:251]
    v_pk_fma_f32 v[120:121], v[120:121], v[248:249], v[250:251]
    v_pk_fma_f32 v[122:123], v[122:123], v[248:249], v[250:251]
    v_pk_fma_f32 v[124:125], v[124:125], v[248:249], v[250:251]
    v_pk_fma_f32 v[126:127], v[126:127], v[248:249], v[250:251]
    v_pk_fma_f32 v[128:129], v[128:129], v[248:249], v[250:251]
    v_pk_fma_f32 v[130:131], v[130:131], v[248:249], v[250:251]
    v_pk_mul_f32 v[104:105], v[104:105], v[48:49]
    v_pk_mul_f32 v[106:107], v[106:107], v[50:51]
    v_pk_mul_f32 v[108:109], v[108:109], v[52:53]
    v_pk_mul_f32 v[110:111], v[110:111], v[54:55]
    v_pk_mul_f32 v[112:113], v[112:113], v[56:57]
    v_pk_mul_f32 v[114:115], v[114:115], v[58:59]
    v_pk_mul_f32 v[116:117], v[116:117], v[60:61]
    v_pk_mul_f32 v[118:119], v[118:119], v[62:63]
    v_pk_mul_f32 v[120:121], v[120:121], v[64:65]
    v_pk_mul_f32 v[122:123], v[122:123], v[66:67]
    v_pk_mul_f32 v[124:125], v[124:125], v[68:69]
    v_pk_mul_f32 v[126:127], v[126:127], v[70:71]
    v_pk_mul_f32 v[128:129], v[128:129], v[72:73]
    v_pk_mul_f32 v[130:131], v[130:131], v[74:75]
    v_exp_f32 v104, v104
    v_exp_f32 v105, v105
    v_exp_f32 v106, v106
    v_exp_f32 v107, v107
    v_exp_f32 v108, v108
    v_exp_f32 v109, v109
    v_exp_f32 v110, v110
    v_exp_f32 v111, v111
    v_exp_f32 v112, v112
    v_exp_f32 v113, v113
    v_exp_f32 v114, v114
    v_exp_f32 v115, v115
    v_exp_f32 v116, v116
    v_exp_f32 v117, v117
    v_exp_f32 v118, v118
    v_exp_f32 v119, v119
    v_exp_f32 v120, v120
    v_exp_f32 v121, v121
    v_exp_f32 v122, v122
    v_exp_f32 v123, v123
    v_exp_f32 v124, v124
    v_exp_f32 v125, v125
    v_exp_f32 v126, v126
    v_exp_f32 v127, v127
    v_exp_f32 v128, v128
    v_exp_f32 v129, v129
    v_exp_f32 v130, v130
    v_exp_f32 v131, v131
    v_add_f32 v104, 1.0, v104
    v_add_f32 v105, 1.0, v105
    v_add_f32 v106, 1.0, v106
    v_add_f32 v107, 1.0, v107
    v_add_f32 v108, 1.0, v108
    v_add_f32 v109, 1.0, v109
    v_add_f32 v110, 1.0, v110
    v_add_f32 v111, 1.0, v111
    v_add_f32 v112, 1.0, v112
    v_add_f32 v113, 1.0, v113
    v_add_f32 v114, 1.0, v114
    v_add_f32 v115, 1.0, v115
    v_add_f32 v116, 1.0, v116
    v_add_f32 v117, 1.0, v117
    v_add_f32 v118, 1.0, v118
    v_add_f32 v119, 1.0, v119
    v_add_f32 v120, 1.0, v120
    v_add_f32 v121, 1.0, v121
    v_add_f32 v122, 1.0, v122
    v_add_f32 v123, 1.0, v123
    v_add_f32 v124, 1.0, v124
    v_add_f32 v125, 1.0, v125
    v_add_f32 v126, 1.0, v126
    v_add_f32 v127, 1.0, v127
    v_add_f32 v128, 1.0, v128
    v_add_f32 v129, 1.0, v129
    v_add_f32 v130, 1.0, v130
    v_add_f32 v131, 1.0, v131
    v_rcp_f32 v104, v104
    v_rcp_f32 v105, v105
    v_rcp_f32 v106, v106
    v_rcp_f32 v107, v107
    v_rcp_f32 v108, v108
    v_rcp_f32 v109, v109
    v_rcp_f32 v110, v110
    v_rcp_f32 v111, v111
    v_rcp_f32 v112, v112
    v_rcp_f32 v113, v113
    v_rcp_f32 v114, v114
    v_rcp_f32 v115, v115
    v_rcp_f32 v116, v116
    v_rcp_f32 v117, v117
    v_rcp_f32 v118, v118
    v_rcp_f32 v119, v119
    v_rcp_f32 v120, v120
    v_rcp_f32 v121, v121
    v_rcp_f32 v122, v122
    v_rcp_f32 v123, v123
    v_rcp_f32 v124, v124
    v_rcp_f32 v125, v125
    v_rcp_f32 v126, v126
    v_rcp_f32 v127, v127
    v_rcp_f32 v128, v128
    v_rcp_f32 v129, v129
    v_rcp_f32 v130, v130
    v_rcp_f32 v131, v131
    s_nop 0
    v_pk_mul_f32 v[48:49], v[48:49], v[104:105]
    v_pk_mul_f32 v[50:51], v[50:51], v[106:107]
    v_pk_mul_f32 v[52:53], v[52:53], v[108:109]
    v_pk_mul_f32 v[54:55], v[54:55], v[110:111]
    v_pk_mul_f32 v[56:57], v[56:57], v[112:113]
    v_pk_mul_f32 v[58:59], v[58:59], v[114:115]
    v_pk_mul_f32 v[60:61], v[60:61], v[116:117]
    v_pk_mul_f32 v[62:63], v[62:63], v[118:119]
    v_pk_mul_f32 v[64:65], v[64:65], v[120:121]
    v_pk_mul_f32 v[66:67], v[66:67], v[122:123]
    v_pk_mul_f32 v[68:69], v[68:69], v[124:125]
    v_pk_mul_f32 v[70:71], v[70:71], v[126:127]
    v_pk_mul_f32 v[72:73], v[72:73], v[128:129]
    v_pk_mul_f32 v[74:75], v[74:75], v[130:131]
    v_cvt_pk_bf16_f32 v196, v48, v49
    v_cvt_pk_bf16_f32 v197, v50, v51
    v_cvt_pk_bf16_f32 v198, v52, v53
    v_cvt_pk_bf16_f32 v199, v54, v55
    v_cvt_pk_bf16_f32 v200, v56, v57
    v_cvt_pk_bf16_f32 v201, v58, v59
    v_cvt_pk_bf16_f32 v202, v60, v61
    v_cvt_pk_bf16_f32 v203, v62, v63
    v_cvt_pk_bf16_f32 v204, v64, v65
    v_cvt_pk_bf16_f32 v205, v66, v67
    v_cvt_pk_bf16_f32 v206, v68, v69
    v_cvt_pk_bf16_f32 v207, v70, v71
    v_cvt_pk_bf16_f32 v208, v72, v73
    v_cvt_pk_bf16_f32 v209, v74, v75
    s_cmp_ge_u32 s90, 12
    s_cbranch_scc1 L_u6_62
    buffer_store_dwordx2 v[208:209], v4, s[8:11], s24 offen offset:0 sc1
L_u6_62:
    buffer_store_dwordx4 v[196:199], v4, s[8:11], s26 offen offset:0 sc1
    buffer_store_dwordx4 v[200:203], v4, s[8:11], s27 offen offset:0 sc1
    buffer_store_dwordx4 v[204:207], v4, s[8:11], s28 offen offset:0 sc1
    v_pk_fma_f32 v[76:77], v[132:133], v[184:185], v[76:77]
    v_pk_fma_f32 v[78:79], v[134:135], v[184:185], v[78:79]
    v_pk_fma_f32 v[80:81], v[136:137], v[184:185], v[80:81]
    v_pk_fma_f32 v[82:83], v[138:139], v[184:185], v[82:83]
    v_pk_fma_f32 v[84:85], v[140:141], v[184:185], v[84:85]
    v_pk_fma_f32 v[86:87], v[142:143], v[184:185], v[86:87]
    v_pk_fma_f32 v[88:89], v[144:145], v[184:185], v[88:89]
    v_pk_fma_f32 v[90:91], v[146:147], v[184:185], v[90:91]
    v_pk_fma_f32 v[92:93], v[148:149], v[184:185], v[92:93]
    v_pk_fma_f32 v[94:95], v[150:151], v[184:185], v[94:95]
    v_pk_fma_f32 v[96:97], v[152:153], v[184:185], v[96:97]
    v_pk_fma_f32 v[98:99], v[154:155], v[184:185], v[98:99]
    v_pk_fma_f32 v[100:101], v[156:157], v[184:185], v[100:101]
    v_pk_fma_f32 v[102:103], v[158:159], v[184:185], v[102:103]
    v_pk_mul_f32 v[76:77], v[76:77], v[186:187]
    v_pk_mul_f32 v[78:79], v[78:79], v[186:187]
    v_pk_mul_f32 v[80:81], v[80:81], v[186:187]
    v_pk_mul_f32 v[82:83], v[82:83], v[186:187]
    v_pk_mul_f32 v[84:85], v[84:85], v[186:187]
    v_pk_mul_f32 v[86:87], v[86:87], v[186:187]
    v_pk_mul_f32 v[88:89], v[88:89], v[186:187]
    v_pk_mul_f32 v[90:91], v[90:91], v[186:187]
    v_pk_mul_f32 v[92:93], v[92:93], v[186:187]
    v_pk_mul_f32 v[94:95], v[94:95], v[186:187]
    v_pk_mul_f32 v[96:97], v[96:97], v[186:187]
    v_pk_mul_f32 v[98:99], v[98:99], v[186:187]
    v_pk_mul_f32 v[100:101], v[100:101], v[186:187]
    v_pk_mul_f32 v[102:103], v[102:103], v[186:187]
    v_pk_mul_f32 v[104:105], v[76:77], v[76:77]
    v_pk_mul_f32 v[106:107], v[78:79], v[78:79]
    v_pk_mul_f32 v[108:109], v[80:81], v[80:81]
    v_pk_mul_f32 v[110:111], v[82:83], v[82:83]
    v_pk_mul_f32 v[112:113], v[84:85], v[84:85]
    v_pk_mul_f32 v[114:115], v[86:87], v[86:87]
    v_pk_mul_f32 v[116:117], v[88:89], v[88:89]
    v_pk_mul_f32 v[118:119], v[90:91], v[90:91]
    v_pk_mul_f32 v[120:121], v[92:93], v[92:93]
    v_pk_mul_f32 v[122:123], v[94:95], v[94:95]
    v_pk_mul_f32 v[124:125], v[96:97], v[96:97]
    v_pk_mul_f32 v[126:127], v[98:99], v[98:99]
    v_pk_mul_f32 v[128:129], v[100:101], v[100:101]
    v_pk_mul_f32 v[130:131], v[102:103], v[102:103]
    v_pk_fma_f32 v[104:105], v[104:105], v[248:249], v[250:251]
    v_pk_fma_f32 v[106:107], v[106:107], v[248:249], v[250:251]
    v_pk_fma_f32 v[108:109], v[108:109], v[248:249], v[250:251]
    v_pk_fma_f32 v[110:111], v[110:111], v[248:249], v[250:251]
    v_pk_fma_f32 v[112:113], v[112:113], v[248:249], v[250:251]
    v_pk_fma_f32 v[114:115], v[114:115], v[248:249], v[250:251]
    v_pk_fma_f32 v[116:117], v[116:117], v[248:249], v[250:251]
    v_pk_fma_f32 v[118:119], v[118:119], v[248:249], v[250:251]
    v_pk_fma_f32 v[120:121], v[120:121], v[248:249], v[250:251]
    v_pk_fma_f32 v[122:123], v[122:123], v[248:249], v[250:251]
    v_pk_fma_f32 v[124:125], v[124:125], v[248:249], v[250:251]
    v_pk_fma_f32 v[126:127], v[126:127], v[248:249], v[250:251]
    v_pk_fma_f32 v[128:129], v[128:129], v[248:249], v[250:251]
    v_pk_fma_f32 v[130:131], v[130:131], v[248:249], v[250:251]
    v_pk_mul_f32 v[104:105], v[104:105], v[76:77]
    v_pk_mul_f32 v[106:107], v[106:107], v[78:79]
    v_pk_mul_f32 v[108:109], v[108:109], v[80:81]
    v_pk_mul_f32 v[110:111], v[110:111], v[82:83]
    v_pk_mul_f32 v[112:113], v[112:113], v[84:85]
    v_pk_mul_f32 v[114:115], v[114:115], v[86:87]
    v_pk_mul_f32 v[116:117], v[116:117], v[88:89]
    v_pk_mul_f32 v[118:119], v[118:119], v[90:91]
    v_pk_mul_f32 v[120:121], v[120:121], v[92:93]
    v_pk_mul_f32 v[122:123], v[122:123], v[94:95]
    v_pk_mul_f32 v[124:125], v[124:125], v[96:97]
    v_pk_mul_f32 v[126:127], v[126:127], v[98:99]
    v_pk_mul_f32 v[128:129], v[128:129], v[100:101]
    v_pk_mul_f32 v[130:131], v[130:131], v[102:103]
    v_exp_f32 v104, v104
    v_exp_f32 v105, v105
    v_exp_f32 v106, v106
    v_exp_f32 v107, v107
    v_exp_f32 v108, v108
    v_exp_f32 v109, v109
    v_exp_f32 v110, v110
    v_exp_f32 v111, v111
    v_exp_f32 v112, v112
    v_exp_f32 v113, v113
    v_exp_f32 v114, v114
    v_exp_f32 v115, v115
    v_exp_f32 v116, v116
    v_exp_f32 v117, v117
    v_exp_f32 v118, v118
    v_exp_f32 v119, v119
    v_exp_f32 v120, v120
    v_exp_f32 v121, v121
    v_exp_f32 v122, v122
    v_exp_f32 v123, v123
    v_exp_f32 v124, v124
    v_exp_f32 v125, v125
    v_exp_f32 v126, v126
    v_exp_f32 v127, v127
    v_exp_f32 v128, v128
    v_exp_f32 v129, v129
    v_exp_f32 v130, v130
    v_exp_f32 v131, v131
    v_add_f32 v104, 1.0, v104
    v_add_f32 v105, 1.0, v105
    v_add_f32 v106, 1.0, v106
    v_add_f32 v107, 1.0, v107
    v_add_f32 v108, 1.0, v108
    v_add_f32 v109, 1.0, v109
    v_add_f32 v110, 1.0, v110
    v_add_f32 v111, 1.0, v111
    v_add_f32 v112, 1.0, v112
    v_add_f32 v113, 1.0, v113
    v_add_f32 v114, 1.0, v114
    v_add_f32 v115, 1.0, v115
    v_add_f32 v116, 1.0, v116
    v_add_f32 v117, 1.0, v117
    v_add_f32 v118, 1.0, v118
    v_add_f32 v119, 1.0, v119
    v_add_f32 v120, 1.0, v120
    v_add_f32 v121, 1.0, v121
    v_add_f32 v122, 1.0, v122
    v_add_f32 v123, 1.0, v123
    v_add_f32 v124, 1.0, v124
    v_add_f32 v125, 1.0, v125
    v_add_f32 v126, 1.0, v126
    v_add_f32 v127, 1.0, v127
    v_add_f32 v128, 1.0, v128
    v_add_f32 v129, 1.0, v129
    v_add_f32 v130, 1.0, v130
    v_add_f32 v131, 1.0, v131
    v_rcp_f32 v104, v104
    v_rcp_f32 v105, v105
    v_rcp_f32 v106, v106
    v_rcp_f32 v107, v107
    v_rcp_f32 v108, v108
    v_rcp_f32 v109, v109
    v_rcp_f32 v110, v110
    v_rcp_f32 v111, v111
    v_rcp_f32 v112, v112
    v_rcp_f32 v113, v113
    v_rcp_f32 v114, v114
    v_rcp_f32 v115, v115
    v_rcp_f32 v116, v116
    v_rcp_f32 v117, v117
    v_rcp_f32 v118, v118
    v_rcp_f32 v119, v119
    v_rcp_f32 v120, v120
    v_rcp_f32 v121, v121
    v_rcp_f32 v122, v122
    v_rcp_f32 v123, v123
    v_rcp_f32 v124, v124
    v_rcp_f32 v125, v125
    v_rcp_f32 v126, v126
    v_rcp_f32 v127, v127
    v_rcp_f32 v128, v128
    v_rcp_f32 v129, v129
    v_rcp_f32 v130, v130
    v_rcp_f32 v131, v131
    s_nop 0
    v_pk_mul_f32 v[76:77], v[76:77], v[104:105]
    v_pk_mul_f32 v[78:79], v[78:79], v[106:107]
    v_pk_mul_f32 v[80:81], v[80:81], v[108:109]
    v_pk_mul_f32 v[82:83], v[82:83], v[110:111]
    v_pk_mul_f32 v[84:85], v[84:85], v[112:113]
    v_pk_mul_f32 v[86:87], v[86:87], v[114:115]
    v_pk_mul_f32 v[88:89], v[88:89], v[116:117]
    v_pk_mul_f32 v[90:91], v[90:91], v[118:119]
    v_pk_mul_f32 v[92:93], v[92:93], v[120:121]
    v_pk_mul_f32 v[94:95], v[94:95], v[122:123]
    v_pk_mul_f32 v[96:97], v[96:97], v[124:125]
    v_pk_mul_f32 v[98:99], v[98:99], v[126:127]
    v_pk_mul_f32 v[100:101], v[100:101], v[128:129]
    v_pk_mul_f32 v[102:103], v[102:103], v[130:131]
    v_cvt_pk_bf16_f32 v212, v76, v77
    v_cvt_pk_bf16_f32 v213, v78, v79
    v_cvt_pk_bf16_f32 v214, v80, v81
    v_cvt_pk_bf16_f32 v215, v82, v83
    v_cvt_pk_bf16_f32 v216, v84, v85
    v_cvt_pk_bf16_f32 v217, v86, v87
    v_cvt_pk_bf16_f32 v218, v88, v89
    v_cvt_pk_bf16_f32 v219, v90, v91
    v_cvt_pk_bf16_f32 v220, v92, v93
    v_cvt_pk_bf16_f32 v221, v94, v95
    v_cvt_pk_bf16_f32 v222, v96, v97
    v_cvt_pk_bf16_f32 v223, v98, v99
    v_cvt_pk_bf16_f32 v224, v100, v101
    v_cvt_pk_bf16_f32 v225, v102, v103
    s_cmp_ge_u32 s90, 12
    s_cbranch_scc1 L_u6_63
    buffer_store_dwordx2 v[224:225], v4, s[8:11], s24 offen offset:256 sc1
L_u6_63:
    buffer_store_dwordx4 v[212:215], v4, s[8:11], s26 offen offset:256 sc1
    buffer_store_dwordx4 v[216:219], v4, s[8:11], s27 offen offset:256 sc1
    buffer_store_dwordx4 v[220:223], v4, s[8:11], s28 offen offset:256 sc1
    s_lshr_b32 s24, s89, 1
    s_mul_i32 s25, s24, 64
    s_lshl_b32 s29, s90, 2
    s_add_u32 s25, s25, s29
    s_add_u32 s25, s25, 57344
    s_waitcnt vmcnt(0)
    v_mov_b32 v244, s79
    v_mov_b32 v245, 0
    s_mov_b64 exec, 1
    s_cmp_eq_u32 s100, 0
    s_cbranch_scc1 L_sv_64
    buffer_store_dword v244, v245, s[8:11], s25 offen
    s_branch L_sv_65
L_sv_64:
    buffer_store_dword v244, v245, s[8:11], s25 offen sc1
L_sv_65:
    s_mov_b64 exec, -1
    s_barrier
    s_lshr_b32 s24, s78, 1
    s_mul_i32 s24, s24, 64
    s_add_u32 s24, s24, 57344
    v_lshlrev_b32 v244, 2, v1
    s_mov_b64 exec, 0xffff
    s_mov_b32 s101, 0x40000
L_poll_66:
    buffer_load_dword v245, v244, s[8:11], s24 offen sc1
    s_waitcnt vmcnt(0)
    v_cmp_ne_u32 vcc, s79, v245
    s_sub_u32 s101, s101, 1
    s_cmp_eq_u64 vcc, 0
    s_cbranch_scc1 L_polld_67
    s_cmp_lg_u32 s101, 0
    s_cbranch_scc1 L_poll_66
L_polld_67:
    s_mov_b64 exec, -1
    v_mul_u32_u24 v4, 33024, v3
    v_lshl_add_u32 v4, v2, 4, v4
    s_lshl_b32 s24, s78, 8
    s_add_u32 s24, s24, 128
    v_add_u32 v4, s24, v4
    s_add_u32 s12, s68, 24379392
    s_addc_u32 s13, s69, 0
    s_mov_b32 s14, 7133184
    s_mov_b32 s15, 0x00020000
    s_mov_b32 s81, 0
    buffer_load_dwordx4 v[164:167], v4, s[12:15], s81 offen sc1
    s_add_u32 s81, s81, 132096
    buffer_load_dwordx4 v[168:171], v4, s[12:15], s81 offen sc1
    s_add_u32 s81, s81, 132096
    buffer_load_dwordx4 v[172:175], v4, s[12:15], s81 offen sc1
    s_add_u32 s81, s81, 132096
    buffer_load_dwordx4 v[176:179], v4, s[12:15], s81 offen sc1
    s_add_u32 s81, s81, 132096
    buffer_load_dwordx4 v[180:183], v4, s[12:15], s81 offen sc1
    s_add_u32 s81, s81, 132096
    buffer_load_dwordx4 v[184:187], v4, s[12:15], s81 offen sc1
    s_add_u32 s81, s81, 132096
    buffer_load_dwordx4 v[188:191], v4, s[12:15], s81 offen sc1
    s_add_u32 s81, s81, 132096
    buffer_load_dwordx4 v[192:195], v4, s[12:15], s81 offen sc1
    s_add_u32 s81, s81, 132096
    buffer_load_dwordx4 v[196:199], v4, s[12:15], s81 offen sc1
    s_add_u32 s81, s81, 132096
    buffer_load_dwordx4 v[200:203], v4, s[12:15], s81 offen sc1
    s_add_u32 s81, s81, 132096
    v_mov_b64 v[48:49], 0
    v_mov_b64 v[50:51], 0
    v_mov_b64 v[52:53], 0
    v_mov_b64 v[54:55], 0
    v_mov_b64 v[56:57], 0
    v_mov_b64 v[58:59], 0
    v_mov_b64 v[60:61], 0
    v_mov_b64 v[62:63], 0
    v_mov_b64 v[64:65], 0
    v_mov_b64 v[66:67], 0
    v_lshlrev_b32 v5, 4, v1
    s_mov_b32 s86, 0
    s_mov_b32 s85, 0
    ds_read_b128 v[104:107], v5 offset:0
    ds_read_b128 v[108:111], v5 offset:1024
    ds_read_b128 v[112:115], v5 offset:2048
    ds_read_b128 v[116:119], v5 offset:3072
    ds_read_b128 v[120:123], v5 offset:4096
    ds_read_b128 v[124:127], v5 offset:5120
    ds_read_b128 v[128:131], v5 offset:6144
    ds_read_b128 v[132:135], v5 offset:7168
    ds_read_b128 v[136:139], v5 offset:8192
    ds_read_b128 v[140:143], v5 offset:9216
L_w4_loop:
    s_waitcnt vmcnt(9) lgkmcnt(5)
    ds_read_b128 v[144:147], v5 offset:10240
    ds_read_b128 v[148:151], v5 offset:11264
    ds_read_b128 v[152:155], v5 offset:12288
    ds_read_b128 v[156:159], v5 offset:13312
    ds_read_b128 v[160:163], v5 offset:14336
    v_mfma_f32_16x16x32_bf16 v[48:51], v[104:107], v[164:167], v[48:51]
    v_mfma_f32_16x16x32_bf16 v[52:55], v[108:111], v[164:167], v[52:55]
    v_mfma_f32_16x16x32_bf16 v[56:59], v[112:115], v[164:167], v[56:59]
    v_mfma_f32_16x16x32_bf16 v[60:63], v[116:119], v[164:167], v[60:63]
    v_mfma_f32_16x16x32_bf16 v[64:67], v[120:123], v[164:167], v[64:67]
    buffer_load_dwordx4 v[204:207], v4, s[12:15], s81 offen sc1
    s_add_u32 s81, s81, 132096
    s_waitcnt vmcnt(9) lgkmcnt(5)
    ds_read_b128 v[104:107], v5 offset:15360
    ds_read_b128 v[108:111], v5 offset:16384
    ds_read_b128 v[112:115], v5 offset:17408
    ds_read_b128 v[116:119], v5 offset:18432
    ds_read_b128 v[120:123], v5 offset:19456
    v_mfma_f32_16x16x32_bf16 v[48:51], v[124:127], v[168:171], v[48:51]
    v_mfma_f32_16x16x32_bf16 v[52:55], v[128:131], v[168:171], v[52:55]
    v_mfma_f32_16x16x32_bf16 v[56:59], v[132:135], v[168:171], v[56:59]
    v_mfma_f32_16x16x32_bf16 v[60:63], v[136:139], v[168:171], v[60:63]
    v_mfma_f32_16x16x32_bf16 v[64:67], v[140:143], v[168:171], v[64:67]
    buffer_load_dwordx4 v[208:211], v4, s[12:15], s81 offen sc1
    s_add_u32 s81, s81, 132096
    s_waitcnt vmcnt(9) lgkmcnt(5)
    ds_read_b128 v[124:127], v5 offset:20480
    ds_read_b128 v[128:131], v5 offset:21504
    ds_read_b128 v[132:135], v5 offset:22528
    ds_read_b128 v[136:139], v5 offset:23552
    ds_read_b128 v[140:143], v5 offset:24576
    v_mfma_f32_16x16x32_bf16 v[48:51], v[144:147], v[172:175], v[48:51]
    v_mfma_f32_16x16x32_bf16 v[52:55], v[148:151], v[172:175], v[52:55]
    v_mfma_f32_16x16x32_bf16 v[56:59], v[152:155], v[172:175], v[56:59]
    v_mfma_f32_16x16x32_bf16 v[60:63], v[156:159], v[172:175], v[60:63]
    v_mfma_f32_16x16x32_bf16 v[64:67], v[160:163], v[172:175], v[64:67]
    buffer_load_dwordx4 v[212:215], v4, s[12:15], s81 offen sc1
    s_add_u32 s81, s81, 132096
    s_waitcnt vmcnt(9) lgkmcnt(5)
    ds_read_b128 v[144:147], v5 offset:25600
    ds_read_b128 v[148:151], v5 offset:26624
    ds_read_b128 v[152:155], v5 offset:27648
    ds_read_b128 v[156:159], v5 offset:28672
    ds_read_b128 v[160:163], v5 offset:29696
    v_mfma_f32_16x16x32_bf16 v[48:51], v[104:107], v[176:179], v[48:51]
    v_mfma_f32_16x16x32_bf16 v[52:55], v[108:111], v[176:179], v[52:55]
    v_mfma_f32_16x16x32_bf16 v[56:59], v[112:115], v[176:179], v[56:59]
    v_mfma_f32_16x16x32_bf16 v[60:63], v[116:119], v[176:179], v[60:63]
    v_mfma_f32_16x16x32_bf16 v[64:67], v[120:123], v[176:179], v[64:67]
    buffer_load_dwordx4 v[216:219], v4, s[12:15], s81 offen sc1
    s_add_u32 s81, s81, 132096
    s_waitcnt vmcnt(9) lgkmcnt(0)
    s_barrier
    s_add_u32 s86, s86, 30720
    s_cmp_eq_u32 s86, 122880
    s_cselect_b32 s86, 0, s86
    v_lshl_add_u32 v5, v1, 4, s86
    ds_read_b128 v[104:107], v5 offset:0
    ds_read_b128 v[108:111], v5 offset:1024
    ds_read_b128 v[112:115], v5 offset:2048
    ds_read_b128 v[116:119], v5 offset:3072
    ds_read_b128 v[120:123], v5 offset:4096
    v_mfma_f32_16x16x32_bf16 v[48:51], v[124:127], v[180:183], v[48:51]
    v_mfma_f32_16x16x32_bf16 v[52:55], v[128:131], v[180:183], v[52:55]
    v_mfma_f32_16x16x32_bf16 v[56:59], v[132:135], v[180:183], v[56:59]
    v_mfma_f32_16x16x32_bf16 v[60:63], v[136:139], v[180:183], v[60:63]
    v_mfma_f32_16x16x32_bf16 v[64:67], v[140:143], v[180:183], v[64:67]
    buffer_load_dwordx4 v[220:223], v4, s[12:15], s81 offen sc1
    s_add_u32 s81, s81, 132096
    s_waitcnt vmcnt(9) lgkmcnt(5)
    ds_read_b128 v[124:127], v5 offset:5120
    ds_read_b128 v[128:131], v5 offset:6144
    ds_read_b128 v[132:135], v5 offset:7168
    ds_read_b128 v[136:139], v5 offset:8192
    ds_read_b128 v[140:143], v5 offset:9216
    v_mfma_f32_16x16x32_bf16 v[48:51], v[144:147], v[184:187], v[48:51]
    v_mfma_f32_16x16x32_bf16 v[52:55], v[148:151], v[184:187], v[52:55]
    v_mfma_f32_16x16x32_bf16 v[56:59], v[152:155], v[184:187], v[56:59]
    v_mfma_f32_16x16x32_bf16 v[60:63], v[156:159], v[184:187], v[60:63]
    v_mfma_f32_16x16x32_bf16 v[64:67], v[160:163], v[184:187], v[64:67]
    buffer_load_dwordx4 v[224:227], v4, s[12:15], s81 offen sc1
    s_add_u32 s81, s81, 132096
    s_waitcnt vmcnt(9) lgkmcnt(5)
    ds_read_b128 v[144:147], v5 offset:10240
    ds_read_b128 v[148:151], v5 offset:11264
    ds_read_b128 v[152:155], v5 offset:12288
    ds_read_b128 v[156:159], v5 offset:13312
    ds_read_b128 v[160:163], v5 offset:14336
    v_mfma_f32_16x16x32_bf16 v[48:51], v[104:107], v[188:191], v[48:51]
    v_mfma_f32_16x16x32_bf16 v[52:55], v[108:111], v[188:191], v[52:55]
    v_mfma_f32_16x16x32_bf16 v[56:59], v[112:115], v[188:191], v[56:59]
    v_mfma_f32_16x16x32_bf16 v[60:63], v[116:119], v[188:191], v[60:63]
    v_mfma_f32_16x16x32_bf16 v[64:67], v[120:123], v[188:191], v[64:67]
    buffer_load_dwordx4 v[228:231], v4, s[12:15], s81 offen sc1
    s_add_u32 s81, s81, 132096
    s_waitcnt vmcnt(9) lgkmcnt(5)
    ds_read_b128 v[104:107], v5 offset:15360
    ds_read_b128 v[108:111], v5 offset:16384
    ds_read_b128 v[112:115], v5 offset:17408
    ds_read_b128 v[116:119], v5 offset:18432
    ds_read_b128 v[120:123], v5 offset:19456
    v_mfma_f32_16x16x32_bf16 v[48:51], v[124:127], v[192:195], v[48:51]
    v_mfma_f32_16x16x32_bf16 v[52:55], v[128:131], v[192:195], v[52:55]
    v_mfma_f32_16x16x32_bf16 v[56:59], v[132:135], v[192:195], v[56:59]
    v_mfma_f32_16x16x32_bf16 v[60:63], v[136:139], v[192:195], v[60:63]
    v_mfma_f32_16x16x32_bf16 v[64:67], v[140:143], v[192:195], v[64:67]
    buffer_load_dwordx4 v[232:235], v4, s[12:15], s81 offen sc1
    s_add_u32 s81, s81, 132096
    s_waitcnt vmcnt(9) lgkmcnt(5)
    ds_read_b128 v[124:127], v5 offset:20480
    ds_read_b128 v[128:131], v5 offset:21504
    ds_read_b128 v[132:135], v5 offset:22528
    ds_read_b128 v[136:139], v5 offset:23552
    ds_read_b128 v[140:143], v5 offset:24576
    v_mfma_f32_16x16x32_bf16 v[48:51], v[144:147], v[196:199], v[48:51]
    v_mfma_f32_16x16x32_bf16 v[52:55], v[148:151], v[196:199], v[52:55]
    v_mfma_f32_16x16x32_bf16 v[56:59], v[152:155], v[196:199], v[56:59]
    v_mfma_f32_16x16x32_bf16 v[60:63], v[156:159], v[196:199], v[60:63]
    v_mfma_f32_16x16x32_bf16 v[64:67], v[160:163], v[196:199], v[64:67]
    buffer_load_dwordx4 v[164:167], v4, s[12:15], s81 offen sc1
    s_add_u32 s81, s81, 132096
    s_waitcnt vmcnt(9) lgkmcnt(5)
    ds_read_b128 v[144:147], v5 offset:25600
    ds_read_b128 v[148:151], v5 offset:26624
    ds_read_b128 v[152:155], v5 offset:27648
    ds_read_b128 v[156:159], v5 offset:28672
    ds_read_b128 v[160:163], v5 offset:29696
    v_mfma_f32_16x16x32_bf16 v[48:51], v[104:107], v[200:203], v[48:51]
    v_mfma_f32_16x16x32_bf16 v[52:55], v[108:111], v[200:203], v[52:55]
    v_mfma_f32_16x16x32_bf16 v[56:59], v[112:115], v[200:203], v[56:59]
    v_mfma_f32_16x16x32_bf16 v[60:63], v[116:119], v[200:203], v[60:63]
    v_mfma_f32_16x16x32_bf16 v[64:67], v[120:123], v[200:203], v[64:67]
    buffer_load_dwordx4 v[168:171], v4, s[12:15], s81 offen sc1
    s_add_u32 s81, s81, 132096
    s_waitcnt vmcnt(9) lgkmcnt(0)
    s_barrier
    s_add_u32 s86, s86, 30720
    s_cmp_eq_u32 s86, 122880
    s_cselect_b32 s86, 0, s86
    v_lshl_add_u32 v5, v1, 4, s86
    ds_read_b128 v[104:107], v5 offset:0
    ds_read_b128 v[108:111], v5 offset:1024
    ds_read_b128 v[112:115], v5 offset:2048
    ds_read_b128 v[116:119], v5 offset:3072
    ds_read_b128 v[120:123], v5 offset:4096
    v_mfma_f32_16x16x32_bf16 v[48:51], v[124:127], v[204:207], v[48:51]
    v_mfma_f32_16x16x32_bf16 v[52:55], v[128:131], v[204:207], v[52:55]
    v_mfma_f32_16x16x32_bf16 v[56:59], v[132:135], v[204:207], v[56:59]
    v_mfma_f32_16x16x32_bf16 v[60:63], v[136:139], v[204:207], v[60:63]
    v_mfma_f32_16x16x32_bf16 v[64:67], v[140:143], v[204:207], v[64:67]
    buffer_load_dwordx4 v[172:175], v4, s[12:15], s81 offen sc1
    s_add_u32 s81, s81, 132096
    s_waitcnt vmcnt(9) lgkmcnt(5)
    ds_read_b128 v[124:127], v5 offset:5120
    ds_read_b128 v[128:131], v5 offset:6144
    ds_read_b128 v[132:135], v5 offset:7168
    ds_read_b128 v[136:139], v5 offset:8192
    ds_read_b128 v[140:143], v5 offset:9216
    v_mfma_f32_16x16x32_bf16 v[48:51], v[144:147], v[208:211], v[48:51]
    v_mfma_f32_16x16x32_bf16 v[52:55], v[148:151], v[208:211], v[52:55]
    v_mfma_f32_16x16x32_bf16 v[56:59], v[152:155], v[208:211], v[56:59]
    v_mfma_f32_16x16x32_bf16 v[60:63], v[156:159], v[208:211], v[60:63]
    v_mfma_f32_16x16x32_bf16 v[64:67], v[160:163], v[208:211], v[64:67]
    buffer_load_dwordx4 v[176:179], v4, s[12:15], s81 offen sc1
    s_add_u32 s81, s81, 132096
    s_waitcnt vmcnt(9) lgkmcnt(5)
    ds_read_b128 v[144:147], v5 offset:10240
    ds_read_b128 v[148:151], v5 offset:11264
    ds_read_b128 v[152:155], v5 offset:12288
    ds_read_b128 v[156:159], v5 offset:13312
    ds_read_b128 v[160:163], v5 offset:14336
    v_mfma_f32_16x16x32_bf16 v[48:51], v[104:107], v[212:215], v[48:51]
    v_mfma_f32_16x16x32_bf16 v[52:55], v[108:111], v[212:215], v[52:55]
    v_mfma_f32_16x16x32_bf16 v[56:59], v[112:115], v[212:215], v[56:59]
    v_mfma_f32_16x16x32_bf16 v[60:63], v[116:119], v[212:215], v[60:63]
    v_mfma_f32_16x16x32_bf16 v[64:67], v[120:123], v[212:215], v[64:67]
    buffer_load_dwordx4 v[180:183], v4, s[12:15], s81 offen sc1
    s_add_u32 s81, s81, 132096
    s_waitcnt vmcnt(9) lgkmcnt(5)
    ds_read_b128 v[104:107], v5 offset:15360
    ds_read_b128 v[108:111], v5 offset:16384
    ds_read_b128 v[112:115], v5 offset:17408
    ds_read_b128 v[116:119], v5 offset:18432
    ds_read_b128 v[120:123], v5 offset:19456
    v_mfma_f32_16x16x32_bf16 v[48:51], v[124:127], v[216:219], v[48:51]
    v_mfma_f32_16x16x32_bf16 v[52:55], v[128:131], v[216:219], v[52:55]
    v_mfma_f32_16x16x32_bf16 v[56:59], v[132:135], v[216:219], v[56:59]
    v_mfma_f32_16x16x32_bf16 v[60:63], v[136:139], v[216:219], v[60:63]
    v_mfma_f32_16x16x32_bf16 v[64:67], v[140:143], v[216:219], v[64:67]
    buffer_load_dwordx4 v[184:187], v4, s[12:15], s81 offen sc1
    s_add_u32 s81, s81, 132096
    s_waitcnt vmcnt(9) lgkmcnt(5)
    ds_read_b128 v[124:127], v5 offset:20480
    ds_read_b128 v[128:131], v5 offset:21504
    ds_read_b128 v[132:135], v5 offset:22528
    ds_read_b128 v[136:139], v5 offset:23552
    ds_read_b128 v[140:143], v5 offset:24576
    v_mfma_f32_16x16x32_bf16 v[48:51], v[144:147], v[220:223], v[48:51]
    v_mfma_f32_16x16x32_bf16 v[52:55], v[148:151], v[220:223], v[52:55]
    v_mfma_f32_16x16x32_bf16 v[56:59], v[152:155], v[220:223], v[56:59]
    v_mfma_f32_16x16x32_bf16 v[60:63], v[156:159], v[220:223], v[60:63]
    v_mfma_f32_16x16x32_bf16 v[64:67], v[160:163], v[220:223], v[64:67]
    buffer_load_dwordx4 v[188:191], v4, s[12:15], s81 offen sc1
    s_add_u32 s81, s81, 132096
    s_waitcnt vmcnt(9) lgkmcnt(5)
    ds_read_b128 v[144:147], v5 offset:25600
    ds_read_b128 v[148:151], v5 offset:26624
    ds_read_b128 v[152:155], v5 offset:27648
    ds_read_b128 v[156:159], v5 offset:28672
    ds_read_b128 v[160:163], v5 offset:29696
    v_mfma_f32_16x16x32_bf16 v[48:51], v[104:107], v[224:227], v[48:51]
    v_mfma_f32_16x16x32_bf16 v[52:55], v[108:111], v[224:227], v[52:55]
    v_mfma_f32_16x16x32_bf16 v[56:59], v[112:115], v[224:227], v[56:59]
    v_mfma_f32_16x16x32_bf16 v[60:63], v[116:119], v[224:227], v[60:63]
    v_mfma_f32_16x16x32_bf16 v[64:67], v[120:123], v[224:227], v[64:67]
    buffer_load_dwordx4 v[192:195], v4, s[12:15], s81 offen sc1
    s_add_u32 s81, s81, 132096
    s_waitcnt vmcnt(9) lgkmcnt(0)
    s_cmp_eq_u32 s85, 2
    s_cbranch_scc1 L_w4_nb_70
    s_barrier
    s_add_u32 s86, s86, 30720
    s_cmp_eq_u32 s86, 122880
    s_cselect_b32 s86, 0, s86
    v_lshl_add_u32 v5, v1, 4, s86
    ds_read_b128 v[104:107], v5 offset:0
    ds_read_b128 v[108:111], v5 offset:1024
    ds_read_b128 v[112:115], v5 offset:2048
    ds_read_b128 v[116:119], v5 offset:3072
    ds_read_b128 v[120:123], v5 offset:4096
L_w4_nb_70:
    v_mfma_f32_16x16x32_bf16 v[48:51], v[124:127], v[228:231], v[48:51]
    v_mfma_f32_16x16x32_bf16 v[52:55], v[128:131], v[228:231], v[52:55]
    v_mfma_f32_16x16x32_bf16 v[56:59], v[132:135], v[228:231], v[56:59]
    v_mfma_f32_16x16x32_bf16 v[60:63], v[136:139], v[228:231], v[60:63]
    v_mfma_f32_16x16x32_bf16 v[64:67], v[140:143], v[228:231], v[64:67]
    buffer_load_dwordx4 v[196:199], v4, s[12:15], s81 offen sc1
    s_add_u32 s81, s81, 132096
    s_waitcnt vmcnt(9) lgkmcnt(5)
    ds_read_b128 v[124:127], v5 offset:5120
    ds_read_b128 v[128:131], v5 offset:6144
    ds_read_b128 v[132:135], v5 offset:7168
    ds_read_b128 v[136:139], v5 offset:8192
    ds_read_b128 v[140:143], v5 offset:9216
    v_mfma_f32_16x16x32_bf16 v[48:51], v[144:147], v[232:235], v[48:51]
    v_mfma_f32_16x16x32_bf16 v[52:55], v[148:151], v[232:235], v[52:55]
    v_mfma_f32_16x16x32_bf16 v[56:59], v[152:155], v[232:235], v[56:59]
    v_mfma_f32_16x16x32_bf16 v[60:63], v[156:159], v[232:235], v[60:63]
    v_mfma_f32_16x16x32_bf16 v[64:67], v[160:163], v[232:235], v[64:67]
    buffer_load_dwordx4 v[200:203], v4, s[12:15], s81 offen sc1
    s_add_u32 s81, s81, 132096
    s_add_u32 s85, s85, 1
    s_cmp_lt_u32 s85, 3
    s_cbranch_scc1 L_w4_loop
    s_waitcnt vmcnt(0) lgkmcnt(0)
    ds_read_b128 v[104:107], v7 offset:960
    ds_read_b128 v[108:111], v7 offset:1024
    ds_read_b128 v[112:115], v7 offset:1088
    ds_read_b128 v[116:119], v7 offset:1152
    ds_read_b128 v[120:123], v7 offset:1216
    v_pk_add_f32 v[48:49], v[48:49], v[28:29]
    v_pk_add_f32 v[50:51], v[50:51], v[30:31]
    v_pk_add_f32 v[52:53], v[52:53], v[32:33]
    v_pk_add_f32 v[54:55], v[54:55], v[34:35]
    v_pk_add_f32 v[56:57], v[56:57], v[36:37]
    v_pk_add_f32 v[58:59], v[58:59], v[38:39]
    v_pk_add_f32 v[60:61], v[60:61], v[40:41]
    v_pk_add_f32 v[62:63], v[62:63], v[42:43]
    v_pk_add_f32 v[64:65], v[64:65], v[44:45]
    v_pk_add_f32 v[66:67], v[66:67], v[46:47]
    s_waitcnt lgkmcnt(0)
    v_pk_fma_f32 v[48:49], v[48:49], v[104:105], v[8:9]
    v_pk_fma_f32 v[50:51], v[50:51], v[106:107], v[10:11]
    v_pk_fma_f32 v[52:53], v[52:53], v[108:109], v[12:13]
    v_pk_fma_f32 v[54:55], v[54:55], v[110:111], v[14:15]
    v_pk_fma_f32 v[56:57], v[56:57], v[112:113], v[16:17]
    v_pk_fma_f32 v[58:59], v[58:59], v[114:115], v[18:19]
    v_pk_fma_f32 v[60:61], v[60:61], v[116:117], v[20:21]
    v_pk_fma_f32 v[62:63], v[62:63], v[118:119], v[22:23]
    v_pk_fma_f32 v[64:65], v[64:65], v[120:121], v[24:25]
    v_pk_fma_f32 v[66:67], v[66:67], v[122:123], v[26:27]
    v_cvt_pk_bf16_f32 v164, v48, v49
    v_cvt_pk_bf16_f32 v165, v50, v51
    v_cvt_pk_bf16_f32 v166, v52, v53
    v_cvt_pk_bf16_f32 v167, v54, v55
    v_cvt_pk_bf16_f32 v168, v56, v57
    v_cvt_pk_bf16_f32 v169, v58, v59
    v_cvt_pk_bf16_f32 v170, v60, v61
    v_cvt_pk_bf16_f32 v171, v62, v63
    v_cvt_pk_bf16_f32 v172, v64, v65
    v_cvt_pk_bf16_f32 v173, v66, v67
    s_mov_b32 s16, s64
    s_mov_b32 s17, s65
    s_mov_b32 s18, 2621440
    s_mov_b32 s19, 0x00020000
    s_mul_i32 s24, s73, 160
    buffer_store_dwordx2 v[164:165], v0, s[16:19], s24 offen offset:0
    buffer_store_dwordx2 v[166:167], v0, s[16:19], s24 offen offset:32
    buffer_store_dwordx2 v[168:169], v0, s[16:19], s24 offen offset:64
    buffer_store_dwordx2 v[170:171], v0, s[16:19], s24 offen offset:96
    buffer_store_dwordx2 v[172:173], v0, s[16:19], s24 offen offset:128
    s_branch L_end
L_hk_entry:
    s_sub_u32 s24, s80, s74
    s_cmp_eq_u32 s24, 0
    s_cbranch_scc1 L_hp_dma
    s_cmp_eq_u32 s24, 3
    s_cbranch_scc1 L_hp_fin
    s_cmp_eq_u32 s24, 5
    s_cbranch_scc1 L_hp_flg
L_hp_ret:
    s_cmp_eq_u32 s80, 0
    s_cbranch_scc1 L_hk_a
    s_cmp_eq_u32 s80, 1
    s_cbranch_scc1 L_hk_b
    s_cmp_eq_u32 s80, 6
    s_cbranch_scc1 L_hk_p
    s_cmp_eq_u32 s80, 7
    s_cbranch_scc1 L_hk_q
    s_cmp_eq_u32 s80, 8
    s_cbranch_scc1 L_hk_r
    s_cmp_eq_u32 s80, 9
    s_cbranch_scc1 L_hk_j
    s_cmp_eq_u32 s80, 10
    s_cbranch_scc1 L_hk_e
    s_cmp_eq_u32 s80, 11
    s_cbranch_scc1 L_hk_f
    s_cmp_eq_u32 s80, 12
    s_cbranch_scc1 L_hk_g
    s_cmp_eq_u32 s80, 13
    s_cbranch_scc1 L_hk_h
    s_cmp_eq_u32 s80, 14
    s_cbranch_scc1 L_hk_i
L_hk_exit:
    s_cmp_eq_u32 s39, 0
    s_cbranch_scc1 L_hk_ret0
    s_cmp_eq_u32 s39, 1
    s_cbranch_scc1 L_hk_ret1
    s_branch L_hk_ret2
L_hp_dma:
    s_cmp_ge_u32 s96, 1232
    s_cbranch_scc1 L_pp_none
    s_mul_i32 s29, s74, 7168
    s_lshl_b32 s31, s87, 7
    s_mov_b32 exec_hi, 0xff
    s_cmp_eq_u32 s87, 5
    s_cbranch_scc1 L_pp_ex
    s_mov_b32 exec_hi, 0xffffff
L_pp_ex:
    s_cmp_eq_u32 s97, 2
    s_cbranch_scc1 L_pp_omk
    s_mul_i32 s25, s32, s35
    s_add_u32 s25, s25, s36
    s_mul_i32 s26, s34, s35
    s_mul_i32 s27, s33, s35
    s_mov_b32 m0, s29
    s_add_u32 s28, s25, s26
    buffer_load_dwordx4 v160, s[12:15], s25 offen lds
    s_add_u32 m0, s29, s31
    s_add_u32 s25, s25, s27
    buffer_load_dwordx4 v160, s[12:15], s28 offen lds
    s_add_u32 s29, s29, s31
    s_add_u32 s29, s29, s31
    s_mov_b32 m0, s29
    s_add_u32 s28, s25, s26
    buffer_load_dwordx4 v160, s[12:15], s25 offen lds
    s_add_u32 m0, s29, s31
    s_add_u32 s25, s25, s27
    buffer_load_dwordx4 v160, s[12:15], s28 offen lds
    s_add_u32 s29, s29, s31
    s_add_u32 s29, s29, s31
    s_mov_b32 m0, s29
    s_add_u32 s28, s25, s26
    buffer_load_dwordx4 v160, s[12:15], s25 offen lds
    s_add_u32 m0, s29, s31
    s_add_u32 s25, s25, s27
    buffer_load_dwordx4 v160, s[12:15], s28 offen lds
    s_add_u32 s29, s29, s31
    s_add_u32 s29, s29, s31
    s_mov_b32 m0, s29
    s_add_u32 s28, s25, s26
    buffer_load_dwordx4 v160, s[12:15], s25 offen lds
    s_add_u32 m0, s29, s31
    s_add_u32 s25, s25, s27
    buffer_load_dwordx4 v160, s[12:15], s28 offen lds
    s_branch L_pp_fin
L_pp_omk:
    s_mov_b32 s37, 0
L_pp_loop:
    s_lshr_b32 s25, s37, 1
    s_and_b32 s26, s37, 1
    s_add_u32 s25, s25, s32
    s_mul_hi_u32 s27, s25, 429496730
    s_mul_i32 s28, s27, 10
    s_sub_u32 s28, s25, s28
    s_mul_i32 s27, s27, 80
    s_cmp_lt_u32 s28, 8
    s_cbranch_scc0 L_pp_om2
    s_lshr_b32 s25, s28, 2
    s_lshl_b32 s25, s25, 1
    s_bfe_u32 s38, s28, 0x10001
    s_add_u32 s25, s25, s38
    s_mul_i32 s25, s25, 20
    s_and_b32 s38, s28, 1
    s_lshl_b32 s38, s38, 2
    s_add_u32 s25, s25, s38
    s_lshl_b32 s26, s26, 3
    s_add_u32 s25, s25, s26
    s_add_u32 s25, s25, s27
    s_branch L_pp_k
L_pp_om2:
    s_sub_u32 s28, s28, 8
    s_lshl_b32 s26, s26, 1
    s_add_u32 s28, s28, s26
    s_mul_i32 s28, s28, 20
    s_add_u32 s25, s28, 16
    s_add_u32 s25, s25, s27
L_pp_k:
    s_mul_i32 s25, s25, s35
    s_add_u32 s25, s25, s36
    s_mov_b32 m0, s29
    s_add_u32 s29, s29, s31
    buffer_load_dwordx4 v160, s[12:15], s25 offen lds
    s_add_u32 s37, s37, 1
    s_cmp_lt_u32 s37, 8
    s_cbranch_scc1 L_pp_loop
L_pp_fin:
    s_mov_b64 exec, -1
L_pp_none:
    s_branch L_hp_ret
L_hp_fin:
    s_cmp_lt_u32 s74, 5
    s_cbranch_scc0 L_w5_71
    s_waitcnt vmcnt(0)
L_w5_71:
    s_cmp_ge_u32 s96, 1232
    s_cbranch_scc1 L_pf_done_72
    s_mul_i32 s29, s74, 7168
    s_lshl_b32 s30, s87, 5
    v_lshlrev_b32 v128, 3, v3
    v_lshrrev_b32 v129, 2, v2
    v_add_u32 v128, v128, v129
    v_mul_u32_u24 v128, s30, v128
    v_add_u32 v128, s29, v128
    v_and_b32 v129, 3, v2
    v_lshl_add_u32 v128, v129, 3, v128
    s_lshl_b32 s31, s30, 2
    v_add_u32 v129, s31, v128
    v_lshlrev_b32 v130, 4, v1
    ds_read_b64_tr_b16 v[136:137], v128 offset:0
    ds_read_b64_tr_b16 v[138:139], v129 offset:0
    ds_read_b64_tr_b16 v[140:141], v128 offset:32
    ds_read_b64_tr_b16 v[142:143], v129 offset:32
    ds_read_b64_tr_b16 v[144:145], v128 offset:64
    ds_read_b64_tr_b16 v[146:147], v129 offset:64
    ds_read_b64_tr_b16 v[148:149], v128 offset:96
    ds_read_b64_tr_b16 v[150:151], v129 offset:96
    ds_read_b64_tr_b16 v[152:153], v128 offset:128
    ds_read_b64_tr_b16 v[154:155], v129 offset:128
    ds_read_b64_tr_b16 v[156:157], v128 offset:160
    ds_read_b64_tr_b16 v[158:159], v129 offset:160
    ds_read_b64_tr_b16 v[160:161], v128 offset:192
    ds_read_b64_tr_b16 v[162:163], v129 offset:192
    v_lshlrev_b32 v131, 3, v3
    s_lshl_b32 s31, s89, 1
    v_add_u32 v131, s31, v131
    v_add_u32 v131, 148096, v131
    s_lshl_b32 s31, s90, 1
    v_add_u32 v132, s31, v131
    ds_read_b64 v[164:165], v131
    ds_read_b64 v[166:167], v132
    ds_read_b64 v[168:169], v131 offset:1280
    ds_read_b64 v[170:171], v132 offset:1280
    s_waitcnt lgkmcnt(0)
    s_add_u32 s31, s86, 0
    buffer_store_dwordx4 v[136:139], v130, s[8:11], s31 offen sc1
    s_add_u32 s31, s86, 1024
    buffer_store_dwordx4 v[140:143], v130, s[8:11], s31 offen sc1
    s_add_u32 s31, s86, 2048
    buffer_store_dwordx4 v[144:147], v130, s[8:11], s31 offen sc1
    s_add_u32 s31, s86, 3072
    buffer_store_dwordx4 v[148:151], v130, s[8:11], s31 offen sc1
    s_add_u32 s31, s86, 4096
    buffer_store_dwordx4 v[152:155], v130, s[8:11], s31 offen sc1
    s_cmp_eq_u32 s87, 5
    s_cbranch_scc1 L_pf5_73
    s_add_u32 s31, s86, 5120
    buffer_store_dwordx4 v[156:159], v130, s[8:11], s31 offen sc1
    s_add_u32 s31, s86, 6144
    buffer_store_dwordx4 v[160:163], v130, s[8:11], s31 offen sc1
L_pf5_73:
    s_cmp_eq_u32 s97, 1
    s_cbranch_scc1 L_pf_w1
    s_cmp_eq_u32 s97, 3
    s_cbranch_scc0 L_pf_done_72
    v_mov_b32 v172, 0x3f803f80
    v_mov_b32 v176, 0
    v_mov_b32 v177, 0
    v_mov_b32 v178, 0
    v_mov_b32 v179, 0
    v_mov_b32 v180, 0
    v_mov_b32 v181, 0
    v_mov_b32 v182, 0
    v_dot2c_f32_bf16 v176, v136, v172
    v_dot2c_f32_bf16 v177, v140, v172
    v_dot2c_f32_bf16 v178, v144, v172
    v_dot2c_f32_bf16 v179, v148, v172
    v_dot2c_f32_bf16 v180, v152, v172
    v_dot2c_f32_bf16 v181, v156, v172
    v_dot2c_f32_bf16 v182, v160, v172
    v_dot2c_f32_bf16 v176, v137, v172
    v_dot2c_f32_bf16 v177, v141, v172
    v_dot2c_f32_bf16 v178, v145, v172
    v_dot2c_f32_bf16 v179, v149, v172
    v_dot2c_f32_bf16 v180, v153, v172
    v_dot2c_f32_bf16 v181, v157, v172
    v_dot2c_f32_bf16 v182, v161, v172
    v_dot2c_f32_bf16 v176, v138, v172
    v_dot2c_f32_bf16 v177, v142, v172
    v_dot2c_f32_bf16 v178, v146, v172
    v_dot2c_f32_bf16 v179, v150, v172
    v_dot2c_f32_bf16 v180, v154, v172
    v_dot2c_f32_bf16 v181, v158, v172
    v_dot2c_f32_bf16 v182, v162, v172
    v_dot2c_f32_bf16 v176, v139, v172
    v_dot2c_f32_bf16 v177, v143, v172
    v_dot2c_f32_bf16 v178, v147, v172
    v_dot2c_f32_bf16 v179, v151, v172
    v_dot2c_f32_bf16 v180, v155, v172
    v_dot2c_f32_bf16 v181, v159, v172
    v_dot2c_f32_bf16 v182, v163, v172
    s_nop 2
    v_mov_b32 v184, v176
    v_mov_b32 v185, v177
    v_mov_b32 v186, v178
    v_mov_b32 v187, v179
    v_mov_b32 v188, v180
    v_mov_b32 v189, v181
    v_mov_b32 v190, v182
    v_permlane32_swap_b32 v176, v184
    v_permlane32_swap_b32 v177, v185
    v_permlane32_swap_b32 v178, v186
    v_permlane32_swap_b32 v179, v187
    v_permlane32_swap_b32 v180, v188
    v_permlane32_swap_b32 v181, v189
    v_permlane32_swap_b32 v182, v190
    v_add_f32 v176, v176, v184
    v_add_f32 v177, v177, v185
    v_add_f32 v178, v178, v186
    v_add_f32 v179, v179, v187
    v_add_f32 v180, v180, v188
    v_add_f32 v181, v181, v189
    v_add_f32 v182, v182, v190
    v_mov_b32 v184, v176
    v_mov_b32 v185, v177
    v_mov_b32 v186, v178
    v_mov_b32 v187, v179
    v_mov_b32 v188, v180
    v_mov_b32 v189, v181
    v_mov_b32 v190, v182
    v_permlane16_swap_b32 v176, v184
    v_permlane16_swap_b32 v177, v185
    v_permlane16_swap_b32 v178, v186
    v_permlane16_swap_b32 v179, v187
    v_permlane16_swap_b32 v180, v188
    v_permlane16_swap_b32 v181, v189
    v_permlane16_swap_b32 v182, v190
    v_add_f32 v176, v176, v184
    v_add_f32 v177, v177, v185
    v_add_f32 v178, v178, v186
    v_add_f32 v179, v179, v187
    v_add_f32 v180, v180, v188
    v_add_f32 v181, v181, v189
    v_add_f32 v182, v182, v190
    s_lshl_b32 s31, s88, 1
    s_add_u32 s31, s31, 24064
    v_lshlrev_b32 v128, 2, v2
    s_mov_b64 exec, 0xffff
    buffer_atomic_add_f32 v176, v128, s[8:11], s31 offen offset:0
    buffer_atomic_add_f32 v177, v128, s[8:11], s31 offen offset:64
    buffer_atomic_add_f32 v178, v128, s[8:11], s31 offen offset:128
    buffer_atomic_add_f32 v179, v128, s[8:11], s31 offen offset:192
    buffer_atomic_add_f32 v180, v128, s[8:11], s31 offen offset:256
    buffer_atomic_add_f32 v181, v128, s[8:11], s31 offen offset:320
    s_cmp_ge_u32 s88, 2688
    s_cbranch_scc1 L_pf_w3e
    buffer_atomic_add_f32 v182, v128, s[8:11], s31 offen offset:384
L_pf_w3e:
    s_mov_b64 exec, -1
    s_branch L_pf_done_72
L_pf_w1:
    v_mov_b32 v172, 0x3f803f80
    v_mov_b32 v176, 0
    v_mov_b32 v177, 0
    v_mov_b32 v178, 0
    v_mov_b32 v179, 0
    v_mov_b32 v180, 0
    v_mov_b32 v181, 0
    v_mov_b32 v182, 0
    v_mov_b32 v183, 0
    v_mov_b32 v184, 0
    v_mov_b32 v185, 0
    v_mov_b32 v186, 0
    v_mov_b32 v187, 0
    v_mov_b32 v188, 0
    v_mov_b32 v189, 0
    v_mov_b32 v190, 0
    v_dot2c_f32_bf16 v176, v136, v164
    v_dot2c_f32_bf16 v181, v136, v168
    v_dot2c_f32_bf16 v186, v136, v172
    v_dot2c_f32_bf16 v177, v140, v164
    v_dot2c_f32_bf16 v182, v140, v168
    v_dot2c_f32_bf16 v187, v140, v172
    v_dot2c_f32_bf16 v178, v144, v164
    v_dot2c_f32_bf16 v183, v144, v168
    v_dot2c_f32_bf16 v188, v144, v172
    v_dot2c_f32_bf16 v179, v148, v164
    v_dot2c_f32_bf16 v184, v148, v168
    v_dot2c_f32_bf16 v189, v148, v172
    v_dot2c_f32_bf16 v180, v152, v164
    v_dot2c_f32_bf16 v185, v152, v168
    v_dot2c_f32_bf16 v190, v152, v172
    v_dot2c_f32_bf16 v176, v137, v165
    v_dot2c_f32_bf16 v181, v137, v169
    v_dot2c_f32_bf16 v186, v137, v172
    v_dot2c_f32_bf16 v177, v141, v165
    v_dot2c_f32_bf16 v182, v141, v169
    v_dot2c_f32_bf16 v187, v141, v172
    v_dot2c_f32_bf16 v178, v145, v165
    v_dot2c_f32_bf16 v183, v145, v169
    v_dot2c_f32_bf16 v188, v145, v172
    v_dot2c_f32_bf16 v179, v149, v165
    v_dot2c_f32_bf16 v184, v149, v169
    v_dot2c_f32_bf16 v189, v149, v172
    v_dot2c_f32_bf16 v180, v153, v165
    v_dot2c_f32_bf16 v185, v153, v169
    v_dot2c_f32_bf16 v190, v153, v172
    v_dot2c_f32_bf16 v176, v138, v166
    v_dot2c_f32_bf16 v181, v138, v170
    v_dot2c_f32_bf16 v186, v138, v172
    v_dot2c_f32_bf16 v177, v142, v166
    v_dot2c_f32_bf16 v182, v142, v170
    v_dot2c_f32_bf16 v187, v142, v172
    v_dot2c_f32_bf16 v178, v146, v166
    v_dot2c_f32_bf16 v183, v146, v170
    v_dot2c_f32_bf16 v188, v146, v172
    v_dot2c_f32_bf16 v179, v150, v166
    v_dot2c_f32_bf16 v184, v150, v170
    v_dot2c_f32_bf16 v189, v150, v172
    v_dot2c_f32_bf16 v180, v154, v166
    v_dot2c_f32_bf16 v185, v154, v170
    v_dot2c_f32_bf16 v190, v154, v172
    v_dot2c_f32_bf16 v176, v139, v167
    v_dot2c_f32_bf16 v181, v139, v171
    v_dot2c_f32_bf16 v186, v139, v172
    v_dot2c_f32_bf16 v177, v143, v167
    v_dot2c_f32_bf16 v182, v143, v171
    v_dot2c_f32_bf16 v187, v143, v172
    v_dot2c_f32_bf16 v178, v147, v167
    v_dot2c_f32_bf16 v183, v147, v171
    v_dot2c_f32_bf16 v188, v147, v172
    v_dot2c_f32_bf16 v179, v151, v167
    v_dot2c_f32_bf16 v184, v151, v171
    v_dot2c_f32_bf16 v189, v151, v172
    v_dot2c_f32_bf16 v180, v155, v167
    v_dot2c_f32_bf16 v185, v155, v171
    v_dot2c_f32_bf16 v190, v155, v172
    s_nop 2
    v_mov_b32 v192, v176
    v_mov_b32 v193, v177
    v_mov_b32 v194, v178
    v_mov_b32 v195, v179
    v_mov_b32 v196, v180
    v_mov_b32 v197, v181
    v_mov_b32 v198, v182
    v_mov_b32 v199, v183
    v_mov_b32 v200, v184
    v_mov_b32 v201, v185
    v_mov_b32 v202, v186
    v_mov_b32 v203, v187
    v_mov_b32 v204, v188
    v_mov_b32 v205, v189
    v_mov_b32 v206, v190
    v_permlane32_swap_b32 v176, v192
    v_permlane32_swap_b32 v177, v193
    v_permlane32_swap_b32 v178, v194
    v_permlane32_swap_b32 v179, v195
    v_permlane32_swap_b32 v180, v196
    v_permlane32_swap_b32 v181, v197
    v_permlane32_swap_b32 v182, v198
    v_permlane32_swap_b32 v183, v199
    v_permlane32_swap_b32 v184, v200
    v_permlane32_swap_b32 v185, v201
    v_permlane32_swap_b32 v186, v202
    v_permlane32_swap_b32 v187, v203
    v_permlane32_swap_b32 v188, v204
    v_permlane32_swap_b32 v189, v205
    v_permlane32_swap_b32 v190, v206
    v_add_f32 v176, v176, v192
    v_add_f32 v177, v177, v193
    v_add_f32 v178, v178, v194
    v_add_f32 v179, v179, v195
    v_add_f32 v180, v180, v196
    v_add_f32 v181, v181, v197
    v_add_f32 v182, v182, v198
    v_add_f32 v183, v183, v199
    v_add_f32 v184, v184, v200
    v_add_f32 v185, v185, v201
    v_add_f32 v186, v186, v202
    v_add_f32 v187, v187, v203
    v_add_f32 v188, v188, v204
    v_add_f32 v189, v189, v205
    v_add_f32 v190, v190, v206
    v_mov_b32 v192, v176
    v_mov_b32 v193, v177
    v_mov_b32 v194, v178
    v_mov_b32 v195, v179
    v_mov_b32 v196, v180
    v_mov_b32 v197, v181
    v_mov_b32 v198, v182
    v_mov_b32 v199, v183
    v_mov_b32 v200, v184
    v_mov_b32 v201, v185
    v_mov_b32 v202, v186
    v_mov_b32 v203, v187
    v_mov_b32 v204, v188
    v_mov_b32 v205, v189
    v_mov_b32 v206, v190
    v_permlane16_swap_b32 v176, v192
    v_permlane16_swap_b32 v177, v193
    v_permlane16_swap_b32 v178, v194
    v_permlane16_swap_b32 v179, v195
    v_permlane16_swap_b32 v180, v196
    v_permlane16_swap_b32 v181, v197
    v_permlane16_swap_b32 v182, v198
    v_permlane16_swap_b32 v183, v199
    v_permlane16_swap_b32 v184, v200
    v_permlane16_swap_b32 v185, v201
    v_permlane16_swap_b32 v186, v202
    v_permlane16_swap_b32 v187, v203
    v_permlane16_swap_b32 v188, v204
    v_permlane16_swap_b32 v189, v205
    v_permlane16_swap_b32 v190, v206
    v_add_f32 v176, v176, v192
    v_add_f32 v177, v177, v193
    v_add_f32 v178, v178, v194
    v_add_f32 v179, v179, v195
    v_add_f32 v180, v180, v196
    v_add_f32 v181, v181, v197
    v_add_f32 v182, v182, v198
    v_add_f32 v183, v183, v199
    v_add_f32 v184, v184, v200
    v_add_f32 v185, v185, v201
    v_add_f32 v186, v186, v202
    v_add_f32 v187, v187, v203
    v_add_f32 v188, v188, v204
    v_add_f32 v189, v189, v205
    v_add_f32 v190, v190, v206
    s_lshl_b32 s31, s88, 1
    s_add_u32 s31, s31, 16384
    v_lshlrev_b32 v128, 2, v2
    s_mov_b64 exec, 0xffff
    s_add_u32 s30, s31, 0
    buffer_atomic_add_f32 v176, v128, s[8:11], s30 offen offset:0
    buffer_atomic_add_f32 v177, v128, s[8:11], s30 offen offset:64
    buffer_atomic_add_f32 v178, v128, s[8:11], s30 offen offset:128
    buffer_atomic_add_f32 v179, v128, s[8:11], s30 offen offset:192
    buffer_atomic_add_f32 v180, v128, s[8:11], s30 offen offset:256
    s_add_u32 s30, s31, 2560
    buffer_atomic_add_f32 v181, v128, s[8:11], s30 offen offset:0
    buffer_atomic_add_f32 v182, v128, s[8:11], s30 offen offset:64
    buffer_atomic_add_f32 v183, v128, s[8:11], s30 offen offset:128
    buffer_atomic_add_f32 v184, v128, s[8:11], s30 offen offset:192
    buffer_atomic_add_f32 v185, v128, s[8:11], s30 offen offset:256
    s_add_u32 s30, s31, 5120
    buffer_atomic_add_f32 v186, v128, s[8:11], s30 offen offset:0
    buffer_atomic_add_f32 v187, v128, s[8:11], s30 offen offset:64
    buffer_atomic_add_f32 v188, v128, s[8:11], s30 offen offset:128
    buffer_atomic_add_f32 v189, v128, s[8:11], s30 offen offset:192
    buffer_atomic_add_f32 v190, v128, s[8:11], s30 offen offset:256
    s_mov_b64 exec, -1
L_pf_done_72:
    s_branch L_hp_ret
L_hp_flg:
    s_cmp_lt_u32 s74, 5
    s_cbranch_scc0 L_w5_74
    s_waitcnt vmcnt(0)
L_w5_74:
    s_cmp_ge_u32 s96, 1232
    s_cbranch_scc1 L_pfl_75
    s_lshl_b32 s24, s96, 2
    s_add_u32 s24, s24, 65536
    v_mov_b32 v128, 0
    v_mov_b32 v129, s79
    s_mov_b64 exec, 1
    buffer_store_dword v129, v128, s[8:11], s24 offen sc1
    s_mov_b64 exec, -1
    v_lshlrev_b32 v130, 4, v1
    s_add_u32 s31, s86, 0
    buffer_load_dwordx4 v[136:139], v130, s[8:11], s31 offen
    s_add_u32 s31, s86, 1024
    buffer_load_dwordx4 v[140:143], v130, s[8:11], s31 offen
    s_add_u32 s31, s86, 2048
    buffer_load_dwordx4 v[144:147], v130, s[8:11], s31 offen
    s_add_u32 s31, s86, 3072
    buffer_load_dwordx4 v[148:151], v130, s[8:11], s31 offen
    s_add_u32 s31, s86, 4096
    buffer_load_dwordx4 v[152:155], v130, s[8:11], s31 offen
    s_cmp_eq_u32 s87, 5
    s_cbranch_scc1 L_pfl_75
    s_add_u32 s31, s86, 5120
    buffer_load_dwordx4 v[156:159], v130, s[8:11], s31 offen
    s_add_u32 s31, s86, 6144
    buffer_load_dwordx4 v[160:163], v130, s[8:11], s31 offen
L_pfl_75:
    s_branch L_hp_ret
L_hk_a:
    s_cmp_ge_u32 s74, 5
    s_cbranch_scc1 L_m2l_76
    v_lshlrev_b32 v128, 4, v0
    s_mov_b32 s28, 31800320
    buffer_load_dwordx4 v[132:135], v128, s[8:11], s28 offen sc1
    s_mov_b32 s28, 31805440
    buffer_load_dwordx4 v[136:139], v128, s[8:11], s28 offen sc1
    s_branch L_m2l_77
L_m2l_76:
    s_cmp_eq_u32 s74, 7
    s_cbranch_scc1 L_m2l_77
    s_mul_i32 s24, s73, 640
    s_mov_b32 s25, 25600
    s_cmp_eq_u32 s74, 5
    s_cselect_b32 s25, 10240, s25
    s_add_u32 s28, s24, s25
    s_add_u32 s28, s28, 31784960
    v_lshlrev_b32 v128, 4, v1
    s_mov_b32 exec_hi, 0xff
    buffer_load_dwordx4 v[132:135], v128, s[8:11], s28 offen sc1
    s_mov_b32 exec_hi, -1
L_m2l_77:
    v_mov_b32 v140, 0
    v_lshlrev_b32 v141, 2, v1
    v_add_u32 v141, 150656, v141
    s_mov_b64 exec, 0xff
    ds_write_b32 v141, v140
    s_mov_b64 exec, -1
    s_branch L_hk_exit
L_hk_b:
    s_cmp_lt_u32 s74, 5
    s_cbranch_scc1 L_hb_78
    s_waitcnt vmcnt(5)
    s_branch L_hb_79
L_hb_78:
    s_waitcnt vmcnt(0)
L_hb_79:
    s_cmp_ge_u32 s74, 5
    s_cbranch_scc1 L_m2b_80
    s_mov_b32 s101, 0x40000
L_cp_82:
    v_cmp_ne_u32 vcc, s79, v133
    v_cmp_ne_u32 s[26:27], s79, v135
    s_or_b64 vcc, vcc, s[26:27]
    v_cmp_ne_u32 s[26:27], s79, v137
    s_or_b64 vcc, vcc, s[26:27]
    v_cmp_ne_u32 s[26:27], s79, v139
    s_or_b64 vcc, vcc, s[26:27]
    s_sub_u32 s101, s101, 1
    s_cmp_eq_u64 vcc, 0
    s_cbranch_scc1 L_cpd_83
    s_cmp_eq_u32 s101, 0
    s_cbranch_scc1 L_cpd_83
    s_sleep 4
    s_cmp_ge_u32 s74, 5
    s_cbranch_scc1 L_m2l_84
    v_lshlrev_b32 v128, 4, v0
    s_mov_b32 s28, 31800320
    buffer_load_dwordx4 v[132:135], v128, s[8:11], s28 offen sc1
    s_mov_b32 s28, 31805440
    buffer_load_dwordx4 v[136:139], v128, s[8:11], s28 offen sc1
    s_branch L_m2l_85
L_m2l_84:
    s_cmp_eq_u32 s74, 7
    s_cbranch_scc1 L_m2l_85
    s_mul_i32 s24, s73, 640
    s_mov_b32 s25, 25600
    s_cmp_eq_u32 s74, 5
    s_cselect_b32 s25, 10240, s25
    s_add_u32 s28, s24, s25
    s_add_u32 s28, s28, 31784960
    v_lshlrev_b32 v128, 4, v1
    s_mov_b32 exec_hi, 0xff
    buffer_load_dwordx4 v[132:135], v128, s[8:11], s28 offen sc1
    s_mov_b32 exec_hi, -1
L_m2l_85:
    s_waitcnt vmcnt(0)
    s_branch L_cp_82
L_cpd_83:
    v_add_f32 v136, 1.0, v136
    v_add_f32 v138, 1.0, v138
    v_cvt_pk_bf16_f32 v140, v136, v138
    v_cvt_pk_bf16_f32 v141, v132, v134
    v_lshlrev_b32 v142, 2, v0
    v_add_u32 v142, 148096, v142
    ds_write_b32 v142, v140
    ds_write_b32 v142, v141 offset:1280
    v_lshlrev_b32 v136, 16, v140
    v_and_b32 v137, 0xffff0000, v140
    v_mov_b32 v133, v134
    s_mul_i32 s24, s73, 40
    v_subrev_u32 v142, s24, v0
    v_cmp_gt_u32 vcc, 40, v142
    v_lshlrev_b32 v142, 3, v142
    v_add_u32 v142, 145408, v142
    s_and_saveexec_b64 s[30:31], vcc
    ds_write_b64 v142, v[136:137] offset:320
    ds_write_b64 v142, v[132:133] offset:640
    s_mov_b64 exec, s[30:31]
    v_add_f32 v144, v136, v137
    v_mul_f32 v145, v136, v136
    v_fmac_f32 v145, v137, v137
    v_mul_f32 v146, v136, v132
    v_fmac_f32 v146, v137, v133
    v_add_f32 v147, v132, v133
    v_mul_f32 v148, v132, v132
    v_fmac_f32 v148, v133, v133
    v_add_f32_dpp v144, v144, v144 row_shr:1 row_mask:0xf bank_mask:0xf
    v_add_f32_dpp v145, v145, v145 row_shr:1 row_mask:0xf bank_mask:0xf
    v_add_f32_dpp v146, v146, v146 row_shr:1 row_mask:0xf bank_mask:0xf
    v_add_f32_dpp v147, v147, v147 row_shr:1 row_mask:0xf bank_mask:0xf
    v_add_f32_dpp v148, v148, v148 row_shr:1 row_mask:0xf bank_mask:0xf
    v_add_f32_dpp v144, v144, v144 row_shr:2 row_mask:0xf bank_mask:0xf
    v_add_f32_dpp v145, v145, v145 row_shr:2 row_mask:0xf bank_mask:0xf
    v_add_f32_dpp v146, v146, v146 row_shr:2 row_mask:0xf bank_mask:0xf
    v_add_f32_dpp v147, v147, v147 row_shr:2 row_mask:0xf bank_mask:0xf
    v_add_f32_dpp v148, v148, v148 row_shr:2 row_mask:0xf bank_mask:0xf
    v_add_f32_dpp v144, v144, v144 row_shr:4 row_mask:0xf bank_mask:0xf
    v_add_f32_dpp v145, v145, v145 row_shr:4 row_mask:0xf bank_mask:0xf
    v_add_f32_dpp v146, v146, v146 row_shr:4 row_mask:0xf bank_mask:0xf
    v_add_f32_dpp v147, v147, v147 row_shr:4 row_mask:0xf bank_mask:0xf
    v_add_f32_dpp v148, v148, v148 row_shr:4 row_mask:0xf bank_mask:0xf
    v_add_f32_dpp v144, v144, v144 row_shr:8 row_mask:0xf bank_mask:0xf
    v_add_f32_dpp v145, v145, v145 row_shr:8 row_mask:0xf bank_mask:0xf
    v_add_f32_dpp v146, v146, v146 row_shr:8 row_mask:0xf bank_mask:0xf
    v_add_f32_dpp v147, v147, v147 row_shr:8 row_mask:0xf bank_mask:0xf
    v_add_f32_dpp v148, v148, v148 row_shr:8 row_mask:0xf bank_mask:0xf
    v_add_f32_dpp v144, v144, v144 row_bcast:15 row_mask:0xa bank_mask:0xf
    v_add_f32_dpp v145, v145, v145 row_bcast:15 row_mask:0xa bank_mask:0xf
    v_add_f32_dpp v146, v146, v146 row_bcast:15 row_mask:0xa bank_mask:0xf
    v_add_f32_dpp v147, v147, v147 row_bcast:15 row_mask:0xa bank_mask:0xf
    v_add_f32_dpp v148, v148, v148 row_bcast:15 row_mask:0xa bank_mask:0xf
    v_add_f32_dpp v144, v144, v144 row_bcast:31 row_mask:0xc bank_mask:0xf
    v_add_f32_dpp v145, v145, v145 row_bcast:31 row_mask:0xc bank_mask:0xf
    v_add_f32_dpp v146, v146, v146 row_bcast:31 row_mask:0xc bank_mask:0xf
    v_add_f32_dpp v147, v147, v147 row_bcast:31 row_mask:0xc bank_mask:0xf
    v_add_f32_dpp v148, v148, v148 row_bcast:31 row_mask:0xc bank_mask:0xf
    v_mov_b32 v149, 150656
    v_cmp_eq_u32 vcc, 63, v1
    s_and_saveexec_b64 s[30:31], vcc
    ds_add_f32 v149, v144
    ds_add_f32 v149, v145 offset:4
    ds_add_f32 v149, v146 offset:8
    ds_add_f32 v149, v147 offset:12
    ds_add_f32 v149, v148 offset:16
    s_mov_b64 exec, s[30:31]
    s_branch L_m2e_81
L_m2b_80:
    s_cmp_eq_u32 s74, 7
    s_cbranch_scc1 L_m2e_81
    s_mov_b32 exec_hi, 0xff
    s_mov_b32 s101, 0x40000
L_cp_86:
    v_cmp_ne_u32 vcc, s79, v133
    v_cmp_ne_u32 s[26:27], s79, v135
    s_or_b64 vcc, vcc, s[26:27]
    s_sub_u32 s101, s101, 1
    s_cmp_eq_u64 vcc, 0
    s_cbranch_scc1 L_cpd_87
    s_cmp_eq_u32 s101, 0
    s_cbranch_scc1 L_cpd_87
    s_sleep 4
    s_cmp_ge_u32 s74, 5
    s_cbranch_scc1 L_m2l_88
    v_lshlrev_b32 v128, 4, v0
    s_mov_b32 s28, 31800320
    buffer_load_dwordx4 v[132:135], v128, s[8:11], s28 offen sc1
    s_mov_b32 s28, 31805440
    buffer_load_dwordx4 v[136:139], v128, s[8:11], s28 offen sc1
    s_branch L_m2l_89
L_m2l_88:
    s_cmp_eq_u32 s74, 7
    s_cbranch_scc1 L_m2l_89
    s_mul_i32 s24, s73, 640
    s_mov_b32 s25, 25600
    s_cmp_eq_u32 s74, 5
    s_cselect_b32 s25, 10240, s25
    s_add_u32 s28, s24, s25
    s_add_u32 s28, s28, 31784960
    v_lshlrev_b32 v128, 4, v1
    s_mov_b32 exec_hi, 0xff
    buffer_load_dwordx4 v[132:135], v128, s[8:11], s28 offen sc1
    s_mov_b32 exec_hi, -1
L_m2l_89:
    s_mov_b32 exec_hi, 0xff
    s_waitcnt vmcnt(0)
    s_branch L_cp_86
L_cpd_87:
    v_mov_b32 v133, v134
    s_cmp_eq_u32 s74, 5
    s_cselect_b32 s24, 0, 960
    s_add_u32 s24, s24, 145408
    v_lshl_add_u32 v142, v1, 3, s24
    ds_write_b64 v142, v[132:133]
    s_mov_b64 exec, -1
L_m2e_81:
    s_branch L_hk_exit
L_hk_p:
    s_cmp_eq_u32 s76, 0
    s_cbranch_scc0 L_hk_exit
    s_branch L_hk_exit
L_hk_q:
    s_cmp_eq_u32 s76, 0
    s_cbranch_scc0 L_hk_exit
    s_branch L_hk_exit
L_hk_r:
    s_cmp_eq_u32 s76, 0
    s_cbranch_scc0 L_hk_exit
    s_branch L_hk_exit
L_hk_j:
    s_cmp_eq_u32 s76, 0
    s_cbranch_scc0 L_hk_exit
    s_lshl_b32 s28, s70, 7
    s_add_u32 s28, s28, 90112
    v_lshlrev_b32 v128, 2, v1
    s_mov_b64 exec, 0xffffffff
    buffer_load_dword v129, v128, s[8:11], s28 offen sc1
    s_mov_b64 exec, -1
    s_mov_b32 s16, s40
    s_mov_b32 s17, s41
    s_mov_b32 s18, 2621440
    s_mov_b32 s19, 0x00020000
    s_lshl_b32 s24, s78, 4
    v_add_u32 v0, s24, v2
    v_mul_u32_u24 v0, 1280, v0
    v_lshl_add_u32 v0, v3, 3, v0
    s_mul_i32 s24, s73, 160
    buffer_load_dwordx2 v[208:209], v0, s[16:19], s24 offen offset:0
    buffer_load_dwordx2 v[210:211], v0, s[16:19], s24 offen offset:32
    buffer_load_dwordx2 v[212:213], v0, s[16:19], s24 offen offset:64
    buffer_load_dwordx2 v[214:215], v0, s[16:19], s24 offen offset:96
    buffer_load_dwordx2 v[216:217], v0, s[16:19], s24 offen offset:128
    v_lshlrev_b32 v130, 12, v1
    s_lshl_b32 s24, s78, 5
    s_add_u32 s24, s24, 32768
    s_mov_b64 exec, 0x7f
    buffer_load_dword v131, v130, s[8:11], s24 offen sc1
    s_mov_b64 exec, 3
    v_lshlrev_b32 v130, 8, v1
    s_lshl_b32 s24, s78, 5
    s_add_u32 s24, s24, 44928
    buffer_load_dword v132, v130, s[8:11], s24 offen sc1
    s_mov_b64 exec, -1
    s_branch L_hk_exit
L_hk_e:
    s_cmp_gt_u32 s74, 4
    s_cbranch_scc1 L_hk_exit
    v_mul_u32_u24 v153, 3277, v1
    v_lshrrev_b32 v153, 16, v153
    v_mul_u32_u24 v154, 20, v153
    v_sub_u32 v154, v1, v154
    v_mul_u32_u24 v153, 160, v153
    v_add_u32 v153, v153, v154
    s_mul_i32 s24, s73, 20
    v_add_u32 v153, s24, v153
    v_lshlrev_b32 v153, 2, v153
    s_mov_b32 s28, 65536
    v_mov_b32 v150, s79
    v_mov_b32 v151, s79
    v_mov_b32 v152, s79
    v_lshlrev_b32 v154, 2, v1
    s_mov_b32 exec_hi, 0x0fffffff
    buffer_load_dword v150, v153, s[8:11], s28 offen sc1
    s_and_b32 s24, s71, 15
    s_mul_i32 s24, s24, 80
    s_add_u32 s24, s24, 67456
    s_mov_b64 exec, 0xfffff
    buffer_load_dword v151, v154, s[8:11], s24 offen sc1
    s_mul_i32 s24, s73, 216
    s_add_u32 s24, s24, 68736
    s_mov_b32 exec_lo, -1
    s_mov_b32 exec_hi, 0x3fffff
    buffer_load_dword v152, v154, s[8:11], s24 offen sc1
    s_mov_b64 exec, -1
    s_branch L_hk_exit
L_hk_f:
    s_cmp_gt_u32 s74, 4
    s_cbranch_scc1 L_hk_exit
    s_waitcnt vmcnt(0)
    s_mov_b32 s101, 0x40000
L_cp_90:
    v_cmp_ne_u32 vcc, s79, v150
    v_cmp_ne_u32 s[26:27], s79, v151
    s_or_b64 vcc, vcc, s[26:27]
    v_cmp_ne_u32 s[26:27], s79, v152
    s_or_b64 vcc, vcc, s[26:27]
    s_sub_u32 s101, s101, 1
    s_cmp_eq_u64 vcc, 0
    s_cbranch_scc1 L_cpd_91
    s_cmp_eq_u32 s101, 0
    s_cbranch_scc1 L_cpd_91
    s_sleep 4
    v_mul_u32_u24 v153, 3277, v1
    v_lshrrev_b32 v153, 16, v153
    v_mul_u32_u24 v154, 20, v153
    v_sub_u32 v154, v1, v154
    v_mul_u32_u24 v153, 160, v153
    v_add_u32 v153, v153, v154
    s_mul_i32 s24, s73, 20
    v_add_u32 v153, s24, v153
    v_lshlrev_b32 v153, 2, v153
    s_mov_b32 s28, 65536
    v_mov_b32 v150, s79
    v_mov_b32 v151, s79
    v_mov_b32 v152, s79
    v_lshlrev_b32 v154, 2, v1
    s_mov_b32 exec_hi, 0x0fffffff
    buffer_load_dword v150, v153, s[8:11], s28 offen sc1
    s_and_b32 s24, s71, 15
    s_mul_i32 s24, s24, 80
    s_add_u32 s24, s24, 67456
    s_mov_b64 exec, 0xfffff
    buffer_load_dword v151, v154, s[8:11], s24 offen sc1
    s_mul_i32 s24, s73, 216
    s_add_u32 s24, s24, 68736
    s_mov_b32 exec_lo, -1
    s_mov_b32 exec_hi, 0x3fffff
    buffer_load_dword v152, v154, s[8:11], s24 offen sc1
    s_mov_b64 exec, -1
    s_waitcnt vmcnt(0)
    s_branch L_cp_90
L_cpd_91:
    s_cmp_eq_u32 s76, 0
    s_cbranch_scc1 L_hk_f0
    s_cmp_lg_u32 s74, 4
    s_cbranch_scc1 L_lcv_92
    s_mul_i32 s24, s73, 320
    v_lshlrev_b32 v204, 4, v1
    s_mov_b64 exec, 0xfffff
    s_add_u32 s25, s24, 16384
    buffer_load_dwordx4 v[208:211], v204, s[8:11], s25 offen sc1
    s_add_u32 s25, s24, 18944
    buffer_load_dwordx4 v[212:215], v204, s[8:11], s25 offen sc1
    s_add_u32 s25, s24, 21504
    buffer_load_dwordx4 v[216:219], v204, s[8:11], s25 offen sc1
    s_and_b32 s24, s71, 15
    s_mul_i32 s25, s24, 448
    s_sub_u32 s26, s24, 12
    s_mul_i32 s26, s26, 384
    s_add_u32 s26, s26, 5376
    s_cmp_lt_u32 s24, 12
    s_cselect_b32 s25, s25, s26
    s_add_u32 s25, s25, 24064
    s_mov_b64 exec, 0xfffffff
    buffer_load_dwordx4 v[220:223], v204, s[8:11], s25 offen sc1
    s_mov_b64 exec, -1
L_lcv_92:
    s_branch L_hk_exit
L_hk_f0:
    s_and_b32 s24, s79, 0xfffffff0
    s_or_b32 s24, s24, s4
    s_mov_b64 exec, 0xffffffff
    v_cmp_ne_u32 vcc, s24, v129
    s_mov_b64 exec, -1
    s_cmp_eq_u64 vcc, 0
    s_cselect_b32 s100, 1, 0
    v_lshlrev_b32 v200, 4, v1
    s_mul_i32 s88, s73, 102400
    s_add_u32 s88, s88, 2359296
    s_mul_i32 s89, s75, 25600
    s_add_u32 s88, s88, s89
    s_mov_b32 m0, s89
    s_add_u32 s89, s89, 4096
    buffer_load_dwordx4 v200, s[8:11], s88 offen  lds
    buffer_load_dwordx4 v200, s[8:11], s88 offen offset:1024  lds
    buffer_load_dwordx4 v200, s[8:11], s88 offen offset:2048  lds
    buffer_load_dwordx4 v200, s[8:11], s88 offen offset:3072  lds
    s_add_u32 s88, s88, 4096
    s_mov_b32 m0, s89
    s_add_u32 s89, s89, 3072
    buffer_load_dwordx4 v200, s[8:11], s88 offen  lds
    buffer_load_dwordx4 v200, s[8:11], s88 offen offset:1024  lds
    buffer_load_dwordx4 v200, s[8:11], s88 offen offset:2048  lds
    s_add_u32 s88, s88, 3072
    s_branch L_hk_exit
L_hk_g:
    s_cmp_eq_u32 s76, 0
    s_cbranch_scc1 L_hk_g0
    s_cmp_lg_u32 s74, 4
    s_cbranch_scc1 L_hk_exit
    s_waitcnt vmcnt(0)
    s_cmp_lg_u32 s74, 4
    s_cbranch_scc1 L_scv_93
    v_add_u32 v204, 146688, v204
    s_mov_b64 exec, 0xfffff
    ds_write_b128 v204, v[208:211]
    ds_write_b128 v204, v[212:215] offset:320
    ds_write_b128 v204, v[216:219] offset:640
    s_mov_b64 exec, 0xfffffff
    ds_write_b128 v204, v[220:223] offset:960
    s_mov_b64 exec, -1
L_scv_93:
    s_branch L_hk_exit
L_hk_g0:
    s_mov_b32 m0, s89
    s_add_u32 s89, s89, 4096
    buffer_load_dwordx4 v200, s[8:11], s88 offen  lds
    buffer_load_dwordx4 v200, s[8:11], s88 offen offset:1024  lds
    buffer_load_dwordx4 v200, s[8:11], s88 offen offset:2048  lds
    buffer_load_dwordx4 v200, s[8:11], s88 offen offset:3072  lds
    s_add_u32 s88, s88, 4096
    s_mov_b32 m0, s89
    s_add_u32 s89, s89, 2048
    buffer_load_dwordx4 v200, s[8:11], s88 offen  lds
    buffer_load_dwordx4 v200, s[8:11], s88 offen offset:1024  lds
    s_add_u32 s88, s88, 2048
    s_branch L_hk_exit
L_hk_h:
    s_cmp_eq_u32 s76, 0
    s_cbranch_scc0 L_hk_exit
    s_mov_b32 m0, s89
    s_add_u32 s89, s89, 4096
    buffer_load_dwordx4 v200, s[8:11], s88 offen  lds
    buffer_load_dwordx4 v200, s[8:11], s88 offen offset:1024  lds
    buffer_load_dwordx4 v200, s[8:11], s88 offen offset:2048  lds
    buffer_load_dwordx4 v200, s[8:11], s88 offen offset:3072  lds
    s_add_u32 s88, s88, 4096
    s_mov_b32 m0, s89
    s_add_u32 s89, s89, 2048
    buffer_load_dwordx4 v200, s[8:11], s88 offen  lds
    buffer_load_dwordx4 v200, s[8:11], s88 offen offset:1024  lds
    s_add_u32 s88, s88, 2048
    s_branch L_hk_exit
L_hk_i:
    s_cmp_eq_u32 s76, 0
    s_cbranch_scc0 L_hk_exit
    s_mov_b32 m0, s89
    s_add_u32 s89, s89, 4096
    buffer_load_dwordx4 v200, s[8:11], s88 offen  lds
    buffer_load_dwordx4 v200, s[8:11], s88 offen offset:1024  lds
    buffer_load_dwordx4 v200, s[8:11], s88 offen offset:2048  lds
    buffer_load_dwordx4 v200, s[8:11], s88 offen offset:3072  lds
    s_add_u32 s88, s88, 4096
    s_mov_b32 m0, s89
    s_add_u32 s89, s89, 2048
    buffer_load_dwordx4 v200, s[8:11], s88 offen  lds
    buffer_load_dwordx4 v200, s[8:11], s88 offen offset:1024  lds
    s_add_u32 s88, s88, 2048
    s_branch L_hk_exit
L_ch_loader:
    v_lshlrev_b32 v200, 4, v1
    s_lshr_b32 s25, s73, 1
    s_mul_i32 s27, s25, 20
    s_and_b32 s26, s73, 1
    s_lshl_b32 s28, s26, 3
    s_add_u32 s25, s27, s28
    s_mul_i32 s25, s25, 33024
    s_lshl_b32 s29, s78, 8
    s_add_u32 s25, s25, s29
    s_add_u32 s25, s25, 16318592
    v_mul_u32_u24 v203, 33024, v3
    v_lshl_add_u32 v203, v2, 4, v203
    v_mov_b32 v204, 0
    v_mov_b32 v205, 0
    v_mov_b32 v206, 0
    v_mov_b32 v207, 0
    buffer_store_dwordx4 v[204:207], v203, s[8:11], s25 offen sc1
    s_add_u32 s25, s25, 132096
    buffer_store_dwordx4 v[204:207], v203, s[8:11], s25 offen sc1
    s_add_u32 s27, s27, 16
    s_mul_i32 s27, s27, 33024
    s_add_u32 s27, s27, s29
    s_add_u32 s27, s27, s28
    s_add_u32 s27, s27, 16318592
    buffer_store_dwordx2 v[204:205], v203, s[8:11], s27 offen sc1
    s_lshl_b32 s27, s78, 12
    s_lshl_b32 s26, s73, 9
    s_add_u32 s27, s27, s26
    s_add_u32 s27, s27, 131072
    v_lshlrev_b32 v203, 4, v1
    s_mov_b64 exec, 0xffffffff
    buffer_store_dwordx4 v[204:207], v203, s[8:11], s27 offen sc1
    s_lshl_b32 s27, s78, 10
    s_lshl_b32 s26, s73, 7
    s_add_u32 s27, s27, s26
    s_add_u32 s27, s27, 655360
    s_mov_b64 exec, 0xff
    buffer_store_dwordx4 v[204:207], v203, s[8:11], s27 offen sc1
    s_mov_b64 exec, -1
    s_waitcnt vmcnt(0)
    s_barrier
    v_mov_b32 v244, 150656
    ds_read_b128 v[164:167], v244
    ds_read_b32 v168, v244 offset:16
    s_waitcnt lgkmcnt(0)
    v_readfirstlane_b32 s91, v164
    v_readfirstlane_b32 s92, v165
    v_readfirstlane_b32 s93, v166
    v_readfirstlane_b32 s94, v167
    v_readfirstlane_b32 s95, v168
    s_barrier
    s_mul_i32 s88, s73, 102400
    s_add_u32 s88, s88, 3407872
    s_mul_i32 s89, s75, 25600
    s_add_u32 s88, s88, s89
    s_mov_b32 s24, 6
L_dr_94:
    s_mov_b32 m0, s89
    s_add_u32 s89, s89, 4096
    buffer_load_dwordx4 v200, s[8:11], s88 offen  lds
    buffer_load_dwordx4 v200, s[8:11], s88 offen offset:1024  lds
    buffer_load_dwordx4 v200, s[8:11], s88 offen offset:2048  lds
    buffer_load_dwordx4 v200, s[8:11], s88 offen offset:3072  lds
    s_add_u32 s88, s88, 4096
    s_sub_u32 s24, s24, 1
    s_cmp_lg_u32 s24, 0
    s_cbranch_scc1 L_dr_94
    s_mov_b32 m0, s89
    s_add_u32 s89, s89, 1024
    buffer_load_dwordx4 v200, s[8:11], s88 offen  lds
    s_add_u32 s88, s88, 1024
    s_and_b32 s90, s71, 15
    s_lshr_b32 s93, s71, 4
    s_waitcnt vmcnt(0)
    s_barrier
    s_mul_i32 s24, s78, 32
    s_add_u32 s24, s24, 36864
    v_lshlrev_b32 v244, 2, v1
    s_mov_b64 exec, 0xff
    s_mov_b32 s101, 0x40000
L_poll_95:
    buffer_load_dword v245, v244, s[8:11], s24 offen sc1
    s_waitcnt vmcnt(0)
    v_cmp_ne_u32 vcc, s79, v245
    s_sub_u32 s101, s101, 1
    s_cmp_eq_u64 vcc, 0
    s_cbranch_scc1 L_polld_96
    s_cmp_lg_u32 s101, 0
    s_cbranch_scc1 L_poll_95
L_polld_96:
    s_mov_b64 exec, -1
    s_lshl_b32 s24, s78, 12
    s_add_u32 s24, s24, 131072
    v_lshlrev_b32 v244, 5, v2
    v_lshl_add_u32 v244, v3, 10, v244
    buffer_load_dwordx4 v[164:167], v244, s[8:11], s24 offen sc1
    buffer_load_dwordx2 v[168:169], v244, s[8:11], s24 offen offset:16 sc1
    buffer_load_dwordx4 v[172:175], v244, s[8:11], s24 offen offset:512 sc1
    buffer_load_dwordx2 v[176:177], v244, s[8:11], s24 offen offset:528 sc1
    s_waitcnt vmcnt(0)
    v_add_f32 v244, v164, v172
    v_add_f32 v245, v165, v173
    v_add_f32 v246, v166, v174
    v_add_f32 v247, v167, v175
    v_add_f32 v248, v168, v176
    v_add_f32 v249, v169, v177
    v_mov_b32 v164, v244
    v_mov_b32 v165, v245
    v_mov_b32 v166, v246
    v_mov_b32 v167, v247
    v_mov_b32 v168, v248
    v_mov_b32 v169, v249
    v_permlane32_swap_b32 v244, v164
    v_permlane32_swap_b32 v245, v165
    v_permlane32_swap_b32 v246, v166
    v_permlane32_swap_b32 v247, v167
    v_permlane32_swap_b32 v248, v168
    v_permlane32_swap_b32 v249, v169
    v_add_f32 v244, v244, v164
    v_add_f32 v245, v245, v165
    v_add_f32 v246, v246, v166
    v_add_f32 v247, v247, v167
    v_add_f32 v248, v248, v168
    v_add_f32 v249, v249, v169
    v_mov_b32 v164, v244
    v_mov_b32 v165, v245
    v_mov_b32 v166, v246
    v_mov_b32 v167, v247
    v_mov_b32 v168, v248
    v_mov_b32 v169, v249
    v_permlane16_swap_b32 v244, v164
    v_permlane16_swap_b32 v245, v165
    v_permlane16_swap_b32 v246, v166
    v_permlane16_swap_b32 v247, v167
    v_permlane16_swap_b32 v248, v168
    v_permlane16_swap_b32 v249, v169
    v_add_f32 v244, v244, v164
    v_add_f32 v245, v245, v165
    v_add_f32 v246, v246, v166
    v_add_f32 v247, v247, v167
    v_add_f32 v248, v248, v168
    v_add_f32 v249, v249, v169
    v_mul_f32 v244, 0x3acccccd, v244
    v_mul_f32 v245, 0x3acccccd, v245
    v_fma_f32 v245, -v244, v244, v245
    v_add_f32 v245, 0x3727c5ac, v245
    v_rsq_f32 v245, v245
    v_mov_b32 v172, s91
    v_fma_f32 v172, -v244, v172, v246
    v_mov_b32 v173, s94
    v_fma_f32 v172, v172, v245, v173
    v_mov_b32 v173, s92
    v_mul_f32 v173, v244, v173
    v_fma_f32 v173, -2.0, v248, v173
    v_fma_f32 v173, v244, v173, v247
    v_mul_f32 v173, v173, v245
    v_mov_b32 v174, s93
    v_fma_f32 v174, -v244, v174, v249
    v_fma_f32 v173, 2.0, v174, v173
    v_mov_b32 v174, s95
    v_fma_f32 v173, v173, v245, v174
    v_mul_f32 v172, 0x3acccccd, v172
    v_mul_f32 v173, 0x3acccccd, v173
    v_fma_f32 v173, -v172, v172, v173
    v_add_f32 v173, 0x3727c5ac, v173
    v_rsq_f32 v249, v173
    s_nop 0
    v_mul_f32 v246, v245, v249
    v_mul_f32 v247, v249, v172
    v_sub_f32 v247, 0, v247
    v_mul_f32 v248, v246, v244
    v_sub_f32 v248, 0, v248
    s_lshl_b32 s24, s75, 10
    s_add_u32 s24, s24, 151808
    v_lshl_add_u32 v250, v2, 5, s24
    s_mov_b64 exec, 0xffff
    ds_write_b128 v250, v[244:247]
    ds_write_b64 v250, v[248:249] offset:16
    s_mov_b64 exec, -1
    s_waitcnt lgkmcnt(0)
    s_barrier
    s_mul_i32 s88, s73, 102400
    s_add_u32 s88, s88, 4456448
    s_mul_i32 s89, s75, 25600
    s_add_u32 s88, s88, s89
    s_mov_b32 s24, 6
L_dr_97:
    s_mov_b32 m0, s89
    s_add_u32 s89, s89, 4096
    buffer_load_dwordx4 v200, s[8:11], s88 offen  lds
    buffer_load_dwordx4 v200, s[8:11], s88 offen offset:1024  lds
    buffer_load_dwordx4 v200, s[8:11], s88 offen offset:2048  lds
    buffer_load_dwordx4 v200, s[8:11], s88 offen offset:3072  lds
    s_add_u32 s88, s88, 4096
    s_sub_u32 s24, s24, 1
    s_cmp_lg_u32 s24, 0
    s_cbranch_scc1 L_dr_97
    s_mov_b32 m0, s89
    s_add_u32 s89, s89, 1024
    buffer_load_dwordx4 v200, s[8:11], s88 offen  lds
    s_add_u32 s88, s88, 1024
    s_and_b32 s90, s71, 15
    s_mul_i32 s88, s90, 143360
    s_add_u32 s88, s88, 5612544
    s_mul_i32 s89, s75, 9216
    s_add_u32 s88, s88, s89
    s_add_u32 s89, s89, 107520
    s_mov_b32 m0, s89
    s_add_u32 s89, s89, 4096
    buffer_load_dwordx4 v200, s[8:11], s88 offen  lds
    buffer_load_dwordx4 v200, s[8:11], s88 offen offset:1024  lds
    buffer_load_dwordx4 v200, s[8:11], s88 offen offset:2048  lds
    buffer_load_dwordx4 v200, s[8:11], s88 offen offset:3072  lds
    s_add_u32 s88, s88, 4096
    s_mov_b32 m0, s89
    s_add_u32 s89, s89, 4096
    buffer_load_dwordx4 v200, s[8:11], s88 offen  lds
    buffer_load_dwordx4 v200, s[8:11], s88 offen offset:1024  lds
    buffer_load_dwordx4 v200, s[8:11], s88 offen offset:2048  lds
    buffer_load_dwordx4 v200, s[8:11], s88 offen offset:3072  lds
    s_add_u32 s88, s88, 4096
    s_cmp_eq_u32 s75, 3
    s_cbranch_scc1 L_w3t_98
    s_mov_b32 m0, s89
    s_add_u32 s89, s89, 1024
    buffer_load_dwordx4 v200, s[8:11], s88 offen  lds
    s_add_u32 s88, s88, 1024
L_w3t_98:
    s_waitcnt vmcnt(8)
    s_barrier
    s_barrier
    s_and_b32 s90, s71, 15
    s_mul_i32 s88, s90, 143360
    s_add_u32 s88, s88, 5505024
    s_mul_i32 s89, s75, 26624
    s_add_u32 s88, s88, s89
    s_mov_b32 s24, 6
L_dr_99:
    s_mov_b32 m0, s89
    s_add_u32 s89, s89, 4096
    buffer_load_dwordx4 v200, s[8:11], s88 offen  lds
    buffer_load_dwordx4 v200, s[8:11], s88 offen offset:1024  lds
    buffer_load_dwordx4 v200, s[8:11], s88 offen offset:2048  lds
    buffer_load_dwordx4 v200, s[8:11], s88 offen offset:3072  lds
    s_add_u32 s88, s88, 4096
    s_sub_u32 s24, s24, 1
    s_cmp_lg_u32 s24, 0
    s_cbranch_scc1 L_dr_99
    s_mov_b32 m0, s89
    s_add_u32 s89, s89, 2048
    buffer_load_dwordx4 v200, s[8:11], s88 offen  lds
    buffer_load_dwordx4 v200, s[8:11], s88 offen offset:1024  lds
    s_add_u32 s88, s88, 2048
    s_cmp_eq_u32 s75, 3
    s_cbranch_scc0 L_w3h_100
    s_mov_b32 m0, s89
    s_add_u32 s89, s89, 1024
    buffer_load_dwordx4 v200, s[8:11], s88 offen  lds
    s_add_u32 s88, s88, 1024
L_w3h_100:
    s_waitcnt vmcnt(0)
    s_barrier
    s_lshl_b32 s92, s70, 4
    s_lshr_b32 s24, s71, 4
    s_lshl_b32 s24, s24, 3
    s_add_u32 s92, s92, s24
    s_lshl_b32 s24, s75, 1
    s_add_u32 s92, s92, s24
    s_mul_i32 s24, s92, 32
    s_add_u32 s24, s24, 49152
    v_lshlrev_b32 v244, 2, v1
    s_mov_b64 exec, 0xffff
    s_mov_b32 s101, 0x40000
L_poll_101:
    buffer_load_dword v245, v244, s[8:11], s24 offen sc1
    s_waitcnt vmcnt(0)
    v_cmp_ne_u32 vcc, s79, v245
    s_sub_u32 s101, s101, 1
    s_cmp_eq_u64 vcc, 0
    s_cbranch_scc1 L_polld_102
    s_cmp_lg_u32 s101, 0
    s_cbranch_scc1 L_poll_101
L_polld_102:
    s_mov_b64 exec, -1
    s_lshl_b32 s24, s92, 10
    s_add_u32 s24, s24, 655360
    v_lshlrev_b32 v244, 3, v2
    v_lshl_add_u32 v244, v3, 8, v244
    buffer_load_dwordx2 v[164:165], v244, s[8:11], s24 offen sc1
    buffer_load_dwordx2 v[166:167], v244, s[8:11], s24 offen offset:128 sc1
    buffer_load_dwordx2 v[168:169], v244, s[8:11], s24 offen offset:1024 sc1
    buffer_load_dwordx2 v[170:171], v244, s[8:11], s24 offen offset:1152 sc1
    s_waitcnt vmcnt(0)
    v_add_f32 v244, v164, v166
    v_add_f32 v245, v165, v167
    v_add_f32 v246, v168, v170
    v_add_f32 v247, v169, v171
    v_mov_b32 v172, v244
    v_mov_b32 v173, v245
    v_mov_b32 v174, v246
    v_mov_b32 v175, v247
    v_permlane32_swap_b32 v244, v172
    v_permlane32_swap_b32 v245, v173
    v_permlane32_swap_b32 v246, v174
    v_permlane32_swap_b32 v247, v175
    v_add_f32 v244, v244, v172
    v_add_f32 v245, v245, v173
    v_add_f32 v246, v246, v174
    v_add_f32 v247, v247, v175
    v_mov_b32 v172, v244
    v_mov_b32 v173, v245
    v_mov_b32 v174, v246
    v_mov_b32 v175, v247
    v_permlane16_swap_b32 v244, v172
    v_permlane16_swap_b32 v245, v173
    v_permlane16_swap_b32 v246, v174
    v_permlane16_swap_b32 v247, v175
    v_add_f32 v244, v244, v172
    v_add_f32 v245, v245, v173
    v_add_f32 v246, v246, v174
    v_add_f32 v247, v247, v175
    v_mul_f32 v244, 0x3acccccd, v244
    v_mul_f32 v245, 0x3acccccd, v245
    v_fma_f32 v245, -v244, v244, v245
    v_add_f32 v245, 0x3727c5ac, v245
    v_rsq_f32 v245, v245
    v_mul_f32 v246, 0x3acccccd, v246
    v_mul_f32 v247, 0x3acccccd, v247
    v_fma_f32 v247, -v246, v246, v247
    v_add_f32 v247, 0x3727c5ac, v247
    v_rsq_f32 v247, v247
    s_lshl_b32 s24, s75, 10
    s_add_u32 s24, s24, 151808
    v_lshl_add_u32 v250, v2, 5, s24
    s_mov_b64 exec, 0xffff
    ds_write_b64 v250, v[244:245]
    ds_write_b64 v250, v[246:247] offset:512
    s_mov_b64 exec, -1
    s_waitcnt lgkmcnt(0)
    s_barrier
    s_mul_i32 s88, s73, 276480
    s_add_u32 s88, s88, 7864320
    s_lshl_b32 s89, s75, 13
    s_add_u32 s88, s88, s89
    s_mov_b32 s90, 0
    s_mov_b32 s91, 0
    v_mov_b32 v201, 0x7ffffff0
    s_cmp_eq_u32 s75, 3
    s_cselect_b64 vcc, -1, 0
    s_nop 0
    v_cndmask_b32 v201, v200, v201, vcc
L_l4_pro:
    s_add_u32 s24, s91, s89
    s_mov_b32 m0, s24
    s_add_u32 s25, s88, 4096
    buffer_load_dwordx4 v200, s[8:11], s88 offen offset:0  lds
    buffer_load_dwordx4 v200, s[8:11], s88 offen offset:1024  lds
    buffer_load_dwordx4 v200, s[8:11], s88 offen offset:2048  lds
    buffer_load_dwordx4 v200, s[8:11], s88 offen offset:3072  lds
    s_add_u32 m0, s24, 4096
    s_add_u32 s88, s88, 30720
    buffer_load_dwordx4 v200, s[8:11], s25 offen offset:0  lds
    buffer_load_dwordx4 v200, s[8:11], s25 offen offset:1024  lds
    s_add_u32 s26, s24, 4096
    s_cmp_eq_u32 s75, 3
    s_cselect_b32 s26, 155648, s26
    s_mov_b32 m0, s26
    s_nop 0
    buffer_load_dwordx4 v201, s[8:11], s25 offen offset:2048  lds
    buffer_load_dwordx4 v201, s[8:11], s25 offen offset:3072  lds
    s_add_u32 s91, s91, 30720
    s_cmp_eq_u32 s91, 122880
    s_cselect_b32 s91, 0, s91
    s_add_u32 s90, s90, 1
    s_cmp_lt_u32 s90, 4
    s_cbranch_scc1 L_l4_pro
    s_waitcnt vmcnt(0)
    s_barrier
    s_mov_b32 s92, 0
L_l4_loop:
    s_waitcnt vmcnt(16)
    s_barrier
    s_cmp_ge_u32 s90, 9
    s_cbranch_scc1 L_l4_dum
    s_add_u32 s24, s91, s89
    s_mov_b32 m0, s24
    s_add_u32 s25, s88, 4096
    buffer_load_dwordx4 v200, s[8:11], s88 offen offset:0  lds
    buffer_load_dwordx4 v200, s[8:11], s88 offen offset:1024  lds
    buffer_load_dwordx4 v200, s[8:11], s88 offen offset:2048  lds
    buffer_load_dwordx4 v200, s[8:11], s88 offen offset:3072  lds
    s_add_u32 m0, s24, 4096
    s_add_u32 s88, s88, 30720
    buffer_load_dwordx4 v200, s[8:11], s25 offen offset:0  lds
    buffer_load_dwordx4 v200, s[8:11], s25 offen offset:1024  lds
    s_add_u32 s26, s24, 4096
    s_cmp_eq_u32 s75, 3
    s_cselect_b32 s26, 155648, s26
    s_mov_b32 m0, s26
    s_nop 0
    buffer_load_dwordx4 v201, s[8:11], s25 offen offset:2048  lds
    buffer_load_dwordx4 v201, s[8:11], s25 offen offset:3072  lds
    s_add_u32 s91, s91, 30720
    s_cmp_eq_u32 s91, 122880
    s_cselect_b32 s91, 0, s91
    s_add_u32 s90, s90, 1
    s_branch L_l4_nx
L_l4_dum:
    s_waitcnt vmcnt(0)
L_l4_nx:
    s_add_u32 s92, s92, 1
    s_cmp_lt_u32 s92, 8
    s_cbranch_scc1 L_l4_loop
    s_waitcnt vmcnt(0)
L_end:
    s_endpgm
.section .rodata,"a"
.p2align 6
.amdhsa_kernel adaLN_cond__grouped_kv_mqa__mixer_s_mlp__prompt_kernel
  .amdhsa_next_free_vgpr 256
  .amdhsa_next_free_sgpr 102
  .amdhsa_accum_offset 256
  .amdhsa_group_segment_fixed_size 0
  .amdhsa_kernarg_size 120
  .amdhsa_user_sgpr_count 2
  .amdhsa_user_sgpr_kernarg_segment_ptr 1
  .amdhsa_system_sgpr_workgroup_id_x 1
  .amdhsa_float_denorm_mode_32 3
  .amdhsa_float_denorm_mode_16_64 3
.end_amdhsa_kernel
```
